```python
import torch

def _softmax(x, axis=-1):
    return torch.softmax(x, dim=axis)
def _gelu(x):
    return torch.nn.functional.gelu(x, approximate="tanh")
def _silu(x):
    return torch.nn.functional.silu(x)
def _sigmoid(x):
    return torch.sigmoid(x)
def _layernorm(x, axis=-1, eps=1e-5):
    m = x.mean(dim=axis, keepdim=True)
    v = x.var(dim=axis, keepdim=True, unbiased=False)
    return (x - m) / torch.sqrt(v + eps)
def _scatter_add(tgt, idx, src, axis=0):
    return tgt.clone().index_add_(axis, idx, src)
def _segment_sum(src, seg, n):
    out = torch.zeros((n,) + src.shape[1:], dtype=src.dtype)
    return out.index_add_(0, seg, src)
def _pad(x, pw):
    flat = tuple(v for pair in reversed(pw) for v in pair)
    return torch.nn.functional.pad(x, flat)

kernel_name = 'gated_mix__grouped_kv_mqa__glu_gated_glu__prompt'

def setup_inputs():

    _w = (lambda a: (lambda t: t.to(torch.bfloat16) if t.is_floating_point() else t)(torch.as_tensor(a)))
    def _A_setup():
        B, S, D, H = 1, 2048, 512, 32
        Dh = D // H
        return {
            "x": _w((lambda *s: torch.randn(*s, dtype=torch.bfloat16) * 0.05)(B, S, D)),
            "wq": _w((lambda *s: torch.randn(*s, dtype=torch.bfloat16) * 0.8)(D, H * Dh)),
            "wk": _w((lambda *s: torch.randn(*s, dtype=torch.bfloat16) * 0.8)(D, Dh)),
            "wv": _w((lambda *s: torch.randn(*s, dtype=torch.bfloat16) * 0.2)(D, Dh)),
            "wo": _w((lambda *s: torch.randn(*s, dtype=torch.bfloat16) * 0.2)(H * Dh, D)),
        }
    _A_in = _A_setup()

    def _B_setup():
        B, S, D, F = 1, 2048, 512, 1792
        return {
            "x": _w((lambda *s: torch.randn(*s, dtype=torch.bfloat16) * 0.05)(B, S, D)),
            "w_gate": _w((lambda *s: torch.randn(*s, dtype=torch.bfloat16) * 0.4)(D, F)),
            "w_up": _w((lambda *s: torch.randn(*s, dtype=torch.bfloat16) * 0.05)(D, F)),
            "w_down": _w((lambda *s: torch.randn(*s, dtype=torch.bfloat16) * 0.05)(F, D)),
        }
    _B_in = _B_setup()

    return {
        "A_x": _A_in["x"],
        "A_wq": _A_in["wq"],
        "A_wk": _A_in["wk"],
        "A_wv": _A_in["wv"],
        "A_wo": _A_in["wo"],
        "B_x": _B_in["x"],
        "B_w_gate": _B_in["w_gate"],
        "B_w_up": _B_in["w_up"],
        "B_w_down": _B_in["w_down"],
        "gate_w": _w((lambda *s: torch.randn(*s, dtype=torch.bfloat16) * 0.05)(512) * 16.0),
    }

def reference(A_x, A_wq, A_wk, A_wv, A_wo, B_x, B_w_gate, B_w_up, B_w_down, gate_w):
    def _A_ref(x, wq, wk, wv, wo):
        B, S, D = x.shape
        H = 32
        Dh = D // H
        q = (lambda x, *d: x.permute(*d))((x @ wq).reshape(B, S, H, Dh), 0, 2, 1, 3)
        k = x @ wk
        v = x @ wv
        scores = torch.einsum("bhqd,bkd->bhqk", q, k) * (Dh ** -0.5)
        p = _softmax(scores, axis=-1)
        o = torch.einsum("bhqk,bkd->bhqd", p, v)
        return (lambda x, *d: x.permute(*d))(o, 0, 2, 1, 3).reshape(B, S, H * Dh) @ wo

    def _B_ref(x, w_gate, w_up, w_down):
        g = torch.einsum("bsd,df->bsf", x, w_gate)
        u = torch.einsum("bsd,df->bsf", x, w_up)
        h = _sigmoid(g) * u
        return torch.einsum("bsf,fd->bsd", h, w_down)

    x = A_x
    g = _sigmoid((x * gate_w).sum(-1, keepdims=True))
    a = _A_ref(x, A_wq, A_wk, A_wv, A_wo)
    b = _B_ref(x, B_w_gate, B_w_up, B_w_down)
    return g * a + (1 - g) * b
```

```asm
; @launch grid=(256,1,1) block=(768,1,1) lds=163840
.amdgcn_target "amdgcn-amd-amdhsa--gfx950"
.text
.globl gated_mix__grouped_kv_mqa__glu_gated_glu__prompt_kernel
.p2align 8
.type gated_mix__grouped_kv_mqa__glu_gated_glu__prompt_kernel,@function
gated_mix__grouped_kv_mqa__glu_gated_glu__prompt_kernel:
    s_cmp_ge_u32 s2, 256
    s_cbranch_scc1 K_END
    s_load_dwordx16 s[4:19], s[0:1], 0
    s_load_dwordx8 s[20:27], s[0:1], 64
    s_load_dwordx2 s[28:29], s[0:1], 96
    s_mov_b32 s100, 131072
    v_lshrrev_b32 v2, 6, v0
    v_and_b32 v1, 63, v0
    v_readfirstlane_b32 s30, v2
    v_lshlrev_b32 v2, 4, v1
    v_lshlrev_b32 v3, 2, v1
    v_lshrrev_b32 v6, 4, v1
    s_and_b32 s57, s2, 7
    s_lshr_b32 s60, s57, 2
    s_and_b32 s61, s57, 1
    s_lshl_b32 s61, s61, 2
    s_and_b32 s57, s57, 2
    s_or_b32 s57, s57, s60
    s_or_b32 s57, s57, s61
    s_lshr_b32 s59, s2, 3
    s_and_b32 s94, s59, 7
    s_lshr_b32 s95, s59, 3
    s_and_b32 s31, s57, 1
    s_lshl_b32 s31, s31, 3
    s_add_u32 s31, s31, s94
    s_lshr_b32 s56, s57, 1
    s_xor_b32 s60, s95, 3
    s_lshl_b32 s60, s60, 2
    s_add_u32 s56, s56, s60
    s_andn2_b32 s76, 1, s57
    s_lshl_b32 s76, s76, 4
    s_and_b32 s60, s57, 2
    s_lshl_b32 s60, s60, 2
    s_add_u32 s76, s76, s60
    s_add_u32 s76, s76, s94
    s_lshr_b32 s77, s57, 2
    s_lshl_b32 s77, s77, 2
    s_add_u32 s77, s77, s95
    s_sub_u32 s3, s30, 8
    s_lshl_b32 s58, s95, 1
    s_add_u32 s58, s58, s94
    s_cmp_ge_u32 s56, 14
    s_cbranch_scc1 SP_START
    s_cmp_lt_u32 s30, 8
    s_cbranch_scc1 COMPUTE
    s_cmp_eq_u32 s3, 3
    s_cbranch_scc1 SERVICE
    s_branch LOADER
SP_START:
    s_lshl_b32 s60, s31, 1
    s_add_u32 s60, s60, s56
    s_sub_u32 s97, s60, 14
    s_lshl_b32 s63, s97, 16
    v_and_b32 v8, 7, v1
    v_xor_b32 v7, v6, v8
    v_lshrrev_b32 v8, 3, v1
    v_lshlrev_b32 v8, 10, v8
    v_lshl_add_u32 v4, v7, 4, v8
    v_xor_b32 v5, 64, v4
    s_waitcnt lgkmcnt(0)
    s_mov_b32 s32, s4
    s_mov_b32 s33, s5
    s_mov_b32 s34, 2097152
    s_mov_b32 s35, 0x00020000
    s_cmp_ge_u32 s30, 8
    s_cbranch_scc1 SP_START_H
    s_lshl_b32 s60, s30, 7
    s_add_u32 s60, s60, s63
    s_lshl_b32 s61, s30, 13
    s_add_u32 s61, s61, 0
    s_add_u32 m0, s61, 0
    s_nop 0
    buffer_load_dwordx4 v4, s[32:35], s60 offen lds
    s_add_u32 m0, s61, 1024
    s_add_u32 s60, s60, 8192
    buffer_load_dwordx4 v5, s[32:35], s60 offen lds
    s_add_u32 m0, s61, 2048
    s_add_u32 s60, s60, 8192
    buffer_load_dwordx4 v4, s[32:35], s60 offen lds
    s_add_u32 m0, s61, 3072
    s_add_u32 s60, s60, 8192
    buffer_load_dwordx4 v5, s[32:35], s60 offen lds
    s_add_u32 m0, s61, 4096
    s_add_u32 s60, s60, 8192
    buffer_load_dwordx4 v4, s[32:35], s60 offen lds
    s_add_u32 m0, s61, 5120
    s_add_u32 s60, s60, 8192
    buffer_load_dwordx4 v5, s[32:35], s60 offen lds
    s_add_u32 m0, s61, 6144
    s_add_u32 s60, s60, 8192
    buffer_load_dwordx4 v4, s[32:35], s60 offen lds
    s_add_u32 m0, s61, 7168
    s_add_u32 s60, s60, 8192
    buffer_load_dwordx4 v5, s[32:35], s60 offen lds
    s_branch COMPUTE
SP_START_H:
    s_cmp_lt_u32 s3, 2
    s_cselect_b32 s36, s8, s10
    s_cselect_b32 s37, s9, s11
    s_mov_b32 s38, 16384
    s_mov_b32 s39, 0x00020000
    s_lshl_b32 s61, s3, 13
    s_and_b32 s62, s61, 0x2000
    s_add_u32 m0, s61, 65536
    s_add_u32 s60, s62, 0
    buffer_load_dwordx4 v2, s[36:39], s60 offen offset:0 lds
    buffer_load_dwordx4 v2, s[36:39], s60 offen offset:1024 lds
    buffer_load_dwordx4 v2, s[36:39], s60 offen offset:2048 lds
    buffer_load_dwordx4 v2, s[36:39], s60 offen offset:3072 lds
    s_add_u32 m0, s61, 69632
    s_add_u32 s60, s62, 4096
    buffer_load_dwordx4 v2, s[36:39], s60 offen offset:0 lds
    buffer_load_dwordx4 v2, s[36:39], s60 offen offset:1024 lds
    buffer_load_dwordx4 v2, s[36:39], s60 offen offset:2048 lds
    buffer_load_dwordx4 v2, s[36:39], s60 offen offset:3072 lds
    s_branch SP_HELPER
LOADER:
    s_lshl_b32 s63, s56, 8
    v_mul_u32_u24 v8, 3584, v6
    v_lshlrev_b32 v7, 1, v6
    v_and_b32 v10, 15, v1
    v_xor_b32 v7, v7, v10
    v_lshl_add_u32 v4, v7, 4, v8
    v_mov_b32 v5, v4
    v_xor_b32 v7, 8, v7
    v_lshl_add_u32 v9, v7, 4, v8
    v_mov_b32 v10, v9
    s_mov_b32 s65, 14336
    s_mov_b32 s66, 229376
    s_lshl_b32 s67, s3, 14
    s_add_u32 s67, s67, 32768
    s_add_u32 s69, s67, 32768
    s_add_u32 s70, s69, 32768
    s_mov_b32 s34, 1835008
    s_cmp_lg_u32 s3, 0
    s_cbranch_scc1 LD_W
    v_and_b32 v8, 7, v1
    v_xor_b32 v7, v6, v8
    v_lshrrev_b32 v8, 3, v1
    v_lshlrev_b32 v8, 10, v8
    v_lshl_add_u32 v4, v7, 4, v8
    v_xor_b32 v5, 64, v4
    v_mov_b32 v9, v4
    v_mov_b32 v10, v5
    s_lshl_b32 s63, s31, 17
    s_mov_b32 s65, 8192
    s_mov_b32 s66, 128
    s_mov_b32 s67, 0
    s_mov_b32 s69, 16384
    s_mov_b32 s70, 147456
    s_mov_b32 s34, 2097152
LD_W:
    s_mov_b32 s35, 0x00020000
    s_waitcnt lgkmcnt(0)
    s_cmp_eq_u32 s3, 1
    s_cselect_b32 s32, s16, s18
    s_cselect_b32 s33, s17, s19
    s_cmp_eq_u32 s3, 0
    s_cselect_b32 s32, s4, s32
    s_cselect_b32 s33, s5, s33
    s_add_u32 s59, s58, 0
    s_and_b32 s59, s59, 7
    s_mul_i32 s60, s66, s59
    s_add_u32 s60, s60, s63
    s_add_u32 m0, s69, 0
    s_nop 0
    buffer_load_dwordx4 v4, s[32:35], s60 offen lds
    s_add_u32 m0, s69, 1024
    s_add_u32 s60, s60, s65
    buffer_load_dwordx4 v5, s[32:35], s60 offen lds
    s_add_u32 m0, s69, 2048
    s_add_u32 s60, s60, s65
    buffer_load_dwordx4 v9, s[32:35], s60 offen lds
    s_add_u32 m0, s69, 3072
    s_add_u32 s60, s60, s65
    buffer_load_dwordx4 v10, s[32:35], s60 offen lds
    s_add_u32 m0, s69, 4096
    s_add_u32 s60, s60, s65
    buffer_load_dwordx4 v4, s[32:35], s60 offen lds
    s_add_u32 m0, s69, 5120
    s_add_u32 s60, s60, s65
    buffer_load_dwordx4 v5, s[32:35], s60 offen lds
    s_add_u32 m0, s69, 6144
    s_add_u32 s60, s60, s65
    buffer_load_dwordx4 v9, s[32:35], s60 offen lds
    s_add_u32 m0, s69, 7168
    s_add_u32 s60, s60, s65
    buffer_load_dwordx4 v10, s[32:35], s60 offen lds
    s_add_u32 m0, s69, 8192
    s_add_u32 s60, s60, s65
    buffer_load_dwordx4 v4, s[32:35], s60 offen lds
    s_add_u32 m0, s69, 9216
    s_add_u32 s60, s60, s65
    buffer_load_dwordx4 v5, s[32:35], s60 offen lds
    s_add_u32 m0, s69, 10240
    s_add_u32 s60, s60, s65
    buffer_load_dwordx4 v9, s[32:35], s60 offen lds
    s_add_u32 m0, s69, 11264
    s_add_u32 s60, s60, s65
    buffer_load_dwordx4 v10, s[32:35], s60 offen lds
    s_add_u32 m0, s69, 12288
    s_add_u32 s60, s60, s65
    buffer_load_dwordx4 v4, s[32:35], s60 offen lds
    s_add_u32 m0, s69, 13312
    s_add_u32 s60, s60, s65
    buffer_load_dwordx4 v5, s[32:35], s60 offen lds
    s_add_u32 m0, s69, 14336
    s_add_u32 s60, s60, s65
    buffer_load_dwordx4 v9, s[32:35], s60 offen lds
    s_add_u32 m0, s69, 15360
    s_add_u32 s60, s60, s65
    buffer_load_dwordx4 v10, s[32:35], s60 offen lds
    s_add_u32 s59, s58, 1
    s_and_b32 s59, s59, 7
    s_mul_i32 s61, s66, s59
    s_add_u32 s61, s61, s63
    s_add_u32 m0, s70, 0
    s_nop 0
    buffer_load_dwordx4 v4, s[32:35], s61 offen lds
    s_add_u32 m0, s70, 1024
    s_add_u32 s61, s61, s65
    buffer_load_dwordx4 v5, s[32:35], s61 offen lds
    s_add_u32 m0, s70, 2048
    s_add_u32 s61, s61, s65
    buffer_load_dwordx4 v9, s[32:35], s61 offen lds
    s_add_u32 m0, s70, 3072
    s_add_u32 s61, s61, s65
    buffer_load_dwordx4 v10, s[32:35], s61 offen lds
    s_add_u32 m0, s70, 4096
    s_add_u32 s61, s61, s65
    buffer_load_dwordx4 v4, s[32:35], s61 offen lds
    s_add_u32 m0, s70, 5120
    s_add_u32 s61, s61, s65
    buffer_load_dwordx4 v5, s[32:35], s61 offen lds
    s_add_u32 m0, s70, 6144
    s_add_u32 s61, s61, s65
    buffer_load_dwordx4 v9, s[32:35], s61 offen lds
    s_add_u32 m0, s70, 7168
    s_add_u32 s61, s61, s65
    buffer_load_dwordx4 v10, s[32:35], s61 offen lds
    s_add_u32 m0, s70, 8192
    s_add_u32 s61, s61, s65
    buffer_load_dwordx4 v4, s[32:35], s61 offen lds
    s_add_u32 m0, s70, 9216
    s_add_u32 s61, s61, s65
    buffer_load_dwordx4 v5, s[32:35], s61 offen lds
    s_add_u32 m0, s70, 10240
    s_add_u32 s61, s61, s65
    buffer_load_dwordx4 v9, s[32:35], s61 offen lds
    s_mov_b32 s48, s28
    s_mov_b32 s49, s29
    s_mov_b32 s50, 16777216
    s_mov_b32 s51, 0x00020000
    s_waitcnt vmcnt(11)
    s_barrier
    s_add_u32 m0, s70, 11264
    s_add_u32 s61, s61, s65
    buffer_load_dwordx4 v10, s[32:35], s61 offen lds
    s_add_u32 m0, s70, 12288
    s_add_u32 s61, s61, s65
    buffer_load_dwordx4 v4, s[32:35], s61 offen lds
    s_add_u32 m0, s70, 13312
    s_add_u32 s61, s61, s65
    buffer_load_dwordx4 v5, s[32:35], s61 offen lds
    s_add_u32 m0, s70, 14336
    s_add_u32 s61, s61, s65
    buffer_load_dwordx4 v9, s[32:35], s61 offen lds
    s_add_u32 m0, s70, 15360
    s_add_u32 s61, s61, s65
    buffer_load_dwordx4 v10, s[32:35], s61 offen lds
    s_add_u32 s59, s58, 2
    s_and_b32 s59, s59, 7
    s_mul_i32 s60, s66, s59
    s_add_u32 s60, s60, s63
    s_add_u32 m0, s67, 0
    s_nop 0
    buffer_load_dwordx4 v4, s[32:35], s60 offen lds
    s_add_u32 m0, s67, 1024
    s_add_u32 s60, s60, s65
    buffer_load_dwordx4 v5, s[32:35], s60 offen lds
    s_add_u32 m0, s67, 2048
    s_add_u32 s60, s60, s65
    buffer_load_dwordx4 v9, s[32:35], s60 offen lds
    s_add_u32 m0, s67, 3072
    s_add_u32 s60, s60, s65
    buffer_load_dwordx4 v10, s[32:35], s60 offen lds
    s_add_u32 m0, s67, 4096
    s_add_u32 s60, s60, s65
    buffer_load_dwordx4 v4, s[32:35], s60 offen lds
    s_add_u32 m0, s67, 5120
    s_add_u32 s60, s60, s65
    buffer_load_dwordx4 v5, s[32:35], s60 offen lds
    s_add_u32 m0, s67, 6144
    s_add_u32 s60, s60, s65
    buffer_load_dwordx4 v9, s[32:35], s60 offen lds
    s_add_u32 m0, s67, 7168
    s_add_u32 s60, s60, s65
    buffer_load_dwordx4 v10, s[32:35], s60 offen lds
    s_add_u32 m0, s67, 8192
    s_add_u32 s60, s60, s65
    buffer_load_dwordx4 v4, s[32:35], s60 offen lds
    s_add_u32 m0, s67, 9216
    s_add_u32 s60, s60, s65
    buffer_load_dwordx4 v5, s[32:35], s60 offen lds
    s_add_u32 m0, s67, 10240
    s_add_u32 s60, s60, s65
    buffer_load_dwordx4 v9, s[32:35], s60 offen lds
    s_waitcnt vmcnt(11)
    s_barrier
    s_add_u32 m0, s67, 11264
    s_add_u32 s60, s60, s65
    buffer_load_dwordx4 v10, s[32:35], s60 offen lds
    s_add_u32 m0, s67, 12288
    s_add_u32 s60, s60, s65
    buffer_load_dwordx4 v4, s[32:35], s60 offen lds
    s_add_u32 m0, s67, 13312
    s_add_u32 s60, s60, s65
    buffer_load_dwordx4 v5, s[32:35], s60 offen lds
    s_add_u32 m0, s67, 14336
    s_add_u32 s60, s60, s65
    buffer_load_dwordx4 v9, s[32:35], s60 offen lds
    s_add_u32 m0, s67, 15360
    s_add_u32 s60, s60, s65
    buffer_load_dwordx4 v10, s[32:35], s60 offen lds
    s_add_u32 s59, s58, 3
    s_and_b32 s59, s59, 7
    s_mul_i32 s61, s66, s59
    s_add_u32 s61, s61, s63
    s_add_u32 m0, s69, 0
    s_nop 0
    buffer_load_dwordx4 v4, s[32:35], s61 offen lds
    s_add_u32 m0, s69, 1024
    s_add_u32 s61, s61, s65
    buffer_load_dwordx4 v5, s[32:35], s61 offen lds
    s_add_u32 m0, s69, 2048
    s_add_u32 s61, s61, s65
    buffer_load_dwordx4 v9, s[32:35], s61 offen lds
    s_add_u32 m0, s69, 3072
    s_add_u32 s61, s61, s65
    buffer_load_dwordx4 v10, s[32:35], s61 offen lds
    s_add_u32 m0, s69, 4096
    s_add_u32 s61, s61, s65
    buffer_load_dwordx4 v4, s[32:35], s61 offen lds
    s_add_u32 m0, s69, 5120
    s_add_u32 s61, s61, s65
    buffer_load_dwordx4 v5, s[32:35], s61 offen lds
    s_add_u32 m0, s69, 6144
    s_add_u32 s61, s61, s65
    buffer_load_dwordx4 v9, s[32:35], s61 offen lds
    s_add_u32 m0, s69, 7168
    s_add_u32 s61, s61, s65
    buffer_load_dwordx4 v10, s[32:35], s61 offen lds
    s_add_u32 m0, s69, 8192
    s_add_u32 s61, s61, s65
    buffer_load_dwordx4 v4, s[32:35], s61 offen lds
    s_add_u32 m0, s69, 9216
    s_add_u32 s61, s61, s65
    buffer_load_dwordx4 v5, s[32:35], s61 offen lds
    s_add_u32 m0, s69, 10240
    s_add_u32 s61, s61, s65
    buffer_load_dwordx4 v9, s[32:35], s61 offen lds
    s_waitcnt vmcnt(11)
    s_barrier
    s_add_u32 m0, s69, 11264
    s_add_u32 s61, s61, s65
    buffer_load_dwordx4 v10, s[32:35], s61 offen lds
    s_add_u32 m0, s69, 12288
    s_add_u32 s61, s61, s65
    buffer_load_dwordx4 v4, s[32:35], s61 offen lds
    s_add_u32 m0, s69, 13312
    s_add_u32 s61, s61, s65
    buffer_load_dwordx4 v5, s[32:35], s61 offen lds
    s_add_u32 m0, s69, 14336
    s_add_u32 s61, s61, s65
    buffer_load_dwordx4 v9, s[32:35], s61 offen lds
    s_add_u32 m0, s69, 15360
    s_add_u32 s61, s61, s65
    buffer_load_dwordx4 v10, s[32:35], s61 offen lds
    s_add_u32 s59, s58, 4
    s_and_b32 s59, s59, 7
    s_mul_i32 s60, s66, s59
    s_add_u32 s60, s60, s63
    s_add_u32 m0, s70, 0
    s_nop 0
    buffer_load_dwordx4 v4, s[32:35], s60 offen lds
    s_add_u32 m0, s70, 1024
    s_add_u32 s60, s60, s65
    buffer_load_dwordx4 v5, s[32:35], s60 offen lds
    s_add_u32 m0, s70, 2048
    s_add_u32 s60, s60, s65
    buffer_load_dwordx4 v9, s[32:35], s60 offen lds
    s_add_u32 m0, s70, 3072
    s_add_u32 s60, s60, s65
    buffer_load_dwordx4 v10, s[32:35], s60 offen lds
    s_add_u32 m0, s70, 4096
    s_add_u32 s60, s60, s65
    buffer_load_dwordx4 v4, s[32:35], s60 offen lds
    s_add_u32 m0, s70, 5120
    s_add_u32 s60, s60, s65
    buffer_load_dwordx4 v5, s[32:35], s60 offen lds
    s_add_u32 m0, s70, 6144
    s_add_u32 s60, s60, s65
    buffer_load_dwordx4 v9, s[32:35], s60 offen lds
    s_add_u32 m0, s70, 7168
    s_add_u32 s60, s60, s65
    buffer_load_dwordx4 v10, s[32:35], s60 offen lds
    s_add_u32 m0, s70, 8192
    s_add_u32 s60, s60, s65
    buffer_load_dwordx4 v4, s[32:35], s60 offen lds
    s_add_u32 m0, s70, 9216
    s_add_u32 s60, s60, s65
    buffer_load_dwordx4 v5, s[32:35], s60 offen lds
    s_add_u32 m0, s70, 10240
    s_add_u32 s60, s60, s65
    buffer_load_dwordx4 v9, s[32:35], s60 offen lds
    s_waitcnt vmcnt(11)
    s_barrier
    s_add_u32 m0, s70, 11264
    s_add_u32 s60, s60, s65
    buffer_load_dwordx4 v10, s[32:35], s60 offen lds
    s_add_u32 m0, s70, 12288
    s_add_u32 s60, s60, s65
    buffer_load_dwordx4 v4, s[32:35], s60 offen lds
    s_add_u32 m0, s70, 13312
    s_add_u32 s60, s60, s65
    buffer_load_dwordx4 v5, s[32:35], s60 offen lds
    s_add_u32 m0, s70, 14336
    s_add_u32 s60, s60, s65
    buffer_load_dwordx4 v9, s[32:35], s60 offen lds
    s_add_u32 m0, s70, 15360
    s_add_u32 s60, s60, s65
    buffer_load_dwordx4 v10, s[32:35], s60 offen lds
    s_add_u32 s59, s58, 5
    s_and_b32 s59, s59, 7
    s_mul_i32 s61, s66, s59
    s_add_u32 s61, s61, s63
    s_add_u32 m0, s67, 0
    s_nop 0
    buffer_load_dwordx4 v4, s[32:35], s61 offen lds
    s_add_u32 m0, s67, 1024
    s_add_u32 s61, s61, s65
    buffer_load_dwordx4 v5, s[32:35], s61 offen lds
    s_add_u32 m0, s67, 2048
    s_add_u32 s61, s61, s65
    buffer_load_dwordx4 v9, s[32:35], s61 offen lds
    s_add_u32 m0, s67, 3072
    s_add_u32 s61, s61, s65
    buffer_load_dwordx4 v10, s[32:35], s61 offen lds
    s_add_u32 m0, s67, 4096
    s_add_u32 s61, s61, s65
    buffer_load_dwordx4 v4, s[32:35], s61 offen lds
    s_add_u32 m0, s67, 5120
    s_add_u32 s61, s61, s65
    buffer_load_dwordx4 v5, s[32:35], s61 offen lds
    s_add_u32 m0, s67, 6144
    s_add_u32 s61, s61, s65
    buffer_load_dwordx4 v9, s[32:35], s61 offen lds
    s_add_u32 m0, s67, 7168
    s_add_u32 s61, s61, s65
    buffer_load_dwordx4 v10, s[32:35], s61 offen lds
    s_add_u32 m0, s67, 8192
    s_add_u32 s61, s61, s65
    buffer_load_dwordx4 v4, s[32:35], s61 offen lds
    s_add_u32 m0, s67, 9216
    s_add_u32 s61, s61, s65
    buffer_load_dwordx4 v5, s[32:35], s61 offen lds
    s_add_u32 m0, s67, 10240
    s_add_u32 s61, s61, s65
    buffer_load_dwordx4 v9, s[32:35], s61 offen lds
    s_waitcnt vmcnt(11)
    s_barrier
    s_add_u32 m0, s67, 11264
    s_add_u32 s61, s61, s65
    buffer_load_dwordx4 v10, s[32:35], s61 offen lds
    s_add_u32 m0, s67, 12288
    s_add_u32 s61, s61, s65
    buffer_load_dwordx4 v4, s[32:35], s61 offen lds
    s_add_u32 m0, s67, 13312
    s_add_u32 s61, s61, s65
    buffer_load_dwordx4 v5, s[32:35], s61 offen lds
    s_add_u32 m0, s67, 14336
    s_add_u32 s61, s61, s65
    buffer_load_dwordx4 v9, s[32:35], s61 offen lds
    s_add_u32 m0, s67, 15360
    s_add_u32 s61, s61, s65
    buffer_load_dwordx4 v10, s[32:35], s61 offen lds
    s_add_u32 s59, s58, 6
    s_and_b32 s59, s59, 7
    s_mul_i32 s60, s66, s59
    s_add_u32 s60, s60, s63
    s_add_u32 m0, s69, 0
    s_nop 0
    buffer_load_dwordx4 v4, s[32:35], s60 offen lds
    s_add_u32 m0, s69, 1024
    s_add_u32 s60, s60, s65
    buffer_load_dwordx4 v5, s[32:35], s60 offen lds
    s_add_u32 m0, s69, 2048
    s_add_u32 s60, s60, s65
    buffer_load_dwordx4 v9, s[32:35], s60 offen lds
    s_add_u32 m0, s69, 3072
    s_add_u32 s60, s60, s65
    buffer_load_dwordx4 v10, s[32:35], s60 offen lds
    s_add_u32 m0, s69, 4096
    s_add_u32 s60, s60, s65
    buffer_load_dwordx4 v4, s[32:35], s60 offen lds
    s_add_u32 m0, s69, 5120
    s_add_u32 s60, s60, s65
    buffer_load_dwordx4 v5, s[32:35], s60 offen lds
    s_add_u32 m0, s69, 6144
    s_add_u32 s60, s60, s65
    buffer_load_dwordx4 v9, s[32:35], s60 offen lds
    s_add_u32 m0, s69, 7168
    s_add_u32 s60, s60, s65
    buffer_load_dwordx4 v10, s[32:35], s60 offen lds
    s_add_u32 m0, s69, 8192
    s_add_u32 s60, s60, s65
    buffer_load_dwordx4 v4, s[32:35], s60 offen lds
    s_add_u32 m0, s69, 9216
    s_add_u32 s60, s60, s65
    buffer_load_dwordx4 v5, s[32:35], s60 offen lds
    s_add_u32 m0, s69, 10240
    s_add_u32 s60, s60, s65
    buffer_load_dwordx4 v9, s[32:35], s60 offen lds
    s_waitcnt vmcnt(11)
    s_barrier
    s_add_u32 m0, s69, 11264
    s_add_u32 s60, s60, s65
    buffer_load_dwordx4 v10, s[32:35], s60 offen lds
    s_add_u32 m0, s69, 12288
    s_add_u32 s60, s60, s65
    buffer_load_dwordx4 v4, s[32:35], s60 offen lds
    s_add_u32 m0, s69, 13312
    s_add_u32 s60, s60, s65
    buffer_load_dwordx4 v5, s[32:35], s60 offen lds
    s_add_u32 m0, s69, 14336
    s_add_u32 s60, s60, s65
    buffer_load_dwordx4 v9, s[32:35], s60 offen lds
    s_add_u32 m0, s69, 15360
    s_add_u32 s60, s60, s65
    buffer_load_dwordx4 v10, s[32:35], s60 offen lds
    s_add_u32 s59, s58, 7
    s_and_b32 s59, s59, 7
    s_mul_i32 s61, s66, s59
    s_add_u32 s61, s61, s63
    s_add_u32 m0, s70, 0
    s_nop 0
    buffer_load_dwordx4 v4, s[32:35], s61 offen lds
    s_add_u32 m0, s70, 1024
    s_add_u32 s61, s61, s65
    buffer_load_dwordx4 v5, s[32:35], s61 offen lds
    s_add_u32 m0, s70, 2048
    s_add_u32 s61, s61, s65
    buffer_load_dwordx4 v9, s[32:35], s61 offen lds
    s_add_u32 m0, s70, 3072
    s_add_u32 s61, s61, s65
    buffer_load_dwordx4 v10, s[32:35], s61 offen lds
    s_add_u32 m0, s70, 4096
    s_add_u32 s61, s61, s65
    buffer_load_dwordx4 v4, s[32:35], s61 offen lds
    s_add_u32 m0, s70, 5120
    s_add_u32 s61, s61, s65
    buffer_load_dwordx4 v5, s[32:35], s61 offen lds
    s_add_u32 m0, s70, 6144
    s_add_u32 s61, s61, s65
    buffer_load_dwordx4 v9, s[32:35], s61 offen lds
    s_add_u32 m0, s70, 7168
    s_add_u32 s61, s61, s65
    buffer_load_dwordx4 v10, s[32:35], s61 offen lds
    s_add_u32 m0, s70, 8192
    s_add_u32 s61, s61, s65
    buffer_load_dwordx4 v4, s[32:35], s61 offen lds
    s_add_u32 m0, s70, 9216
    s_add_u32 s61, s61, s65
    buffer_load_dwordx4 v5, s[32:35], s61 offen lds
    s_add_u32 m0, s70, 10240
    s_add_u32 s61, s61, s65
    buffer_load_dwordx4 v9, s[32:35], s61 offen lds
    s_waitcnt vmcnt(11)
    s_barrier
    s_add_u32 m0, s70, 11264
    s_add_u32 s61, s61, s65
    buffer_load_dwordx4 v10, s[32:35], s61 offen lds
    s_add_u32 m0, s70, 12288
    s_add_u32 s61, s61, s65
    buffer_load_dwordx4 v4, s[32:35], s61 offen lds
    s_add_u32 m0, s70, 13312
    s_add_u32 s61, s61, s65
    buffer_load_dwordx4 v5, s[32:35], s61 offen lds
    s_add_u32 m0, s70, 14336
    s_add_u32 s61, s61, s65
    buffer_load_dwordx4 v9, s[32:35], s61 offen lds
    s_add_u32 m0, s70, 15360
    s_add_u32 s61, s61, s65
    buffer_load_dwordx4 v10, s[32:35], s61 offen lds
    s_mov_b32 s59, 0x40300
    s_lshl_b32 s62, s3, 3
    s_lshr_b32 s59, s59, s62
    s_and_b32 s59, s59, 15
    s_add_u32 s62, s59, s94
    s_and_b32 s62, s62, 7
    s_lshl_b32 s62, s62, 14
    s_add_u32 s62, s62, 4194304
    s_lshl_b32 s59, s59, 14
    s_add_u32 m0, s59, 0
    s_add_u32 s64, s62, 0
    buffer_load_dwordx4 v2, s[48:51], s64 offen offset:0 sc1 lds
    buffer_load_dwordx4 v2, s[48:51], s64 offen offset:1024 sc1 lds
    buffer_load_dwordx4 v2, s[48:51], s64 offen offset:2048 sc1 lds
    buffer_load_dwordx4 v2, s[48:51], s64 offen offset:3072 sc1 lds
    s_add_u32 m0, s59, 4096
    s_add_u32 s64, s62, 4096
    buffer_load_dwordx4 v2, s[48:51], s64 offen offset:0 sc1 lds
    buffer_load_dwordx4 v2, s[48:51], s64 offen offset:1024 sc1 lds
    buffer_load_dwordx4 v2, s[48:51], s64 offen offset:2048 sc1 lds
    buffer_load_dwordx4 v2, s[48:51], s64 offen offset:3072 sc1 lds
    s_add_u32 m0, s59, 8192
    s_add_u32 s64, s62, 8192
    buffer_load_dwordx4 v2, s[48:51], s64 offen offset:0 sc1 lds
    buffer_load_dwordx4 v2, s[48:51], s64 offen offset:1024 sc1 lds
    buffer_load_dwordx4 v2, s[48:51], s64 offen offset:2048 sc1 lds
    buffer_load_dwordx4 v2, s[48:51], s64 offen offset:3072 sc1 lds
    s_add_u32 m0, s59, 12288
    s_add_u32 s64, s62, 12288
    buffer_load_dwordx4 v2, s[48:51], s64 offen offset:0 sc1 lds
    buffer_load_dwordx4 v2, s[48:51], s64 offen offset:1024 sc1 lds
    buffer_load_dwordx4 v2, s[48:51], s64 offen offset:2048 sc1 lds
    buffer_load_dwordx4 v2, s[48:51], s64 offen offset:3072 sc1 lds
    s_waitcnt vmcnt(16)
    s_barrier
    s_mov_b32 s59, 0x60501
    s_lshl_b32 s62, s3, 3
    s_lshr_b32 s59, s59, s62
    s_and_b32 s59, s59, 15
    s_add_u32 s62, s59, s94
    s_and_b32 s62, s62, 7
    s_lshl_b32 s62, s62, 14
    s_add_u32 s62, s62, 4194304
    s_lshl_b32 s59, s59, 14
    s_add_u32 m0, s59, 0
    s_add_u32 s64, s62, 0
    buffer_load_dwordx4 v2, s[48:51], s64 offen offset:0 sc1 lds
    buffer_load_dwordx4 v2, s[48:51], s64 offen offset:1024 sc1 lds
    buffer_load_dwordx4 v2, s[48:51], s64 offen offset:2048 sc1 lds
    buffer_load_dwordx4 v2, s[48:51], s64 offen offset:3072 sc1 lds
    s_add_u32 m0, s59, 4096
    s_add_u32 s64, s62, 4096
    buffer_load_dwordx4 v2, s[48:51], s64 offen offset:0 sc1 lds
    buffer_load_dwordx4 v2, s[48:51], s64 offen offset:1024 sc1 lds
    buffer_load_dwordx4 v2, s[48:51], s64 offen offset:2048 sc1 lds
    buffer_load_dwordx4 v2, s[48:51], s64 offen offset:3072 sc1 lds
    s_add_u32 m0, s59, 8192
    s_add_u32 s64, s62, 8192
    buffer_load_dwordx4 v2, s[48:51], s64 offen offset:0 sc1 lds
    buffer_load_dwordx4 v2, s[48:51], s64 offen offset:1024 sc1 lds
    buffer_load_dwordx4 v2, s[48:51], s64 offen offset:2048 sc1 lds
    buffer_load_dwordx4 v2, s[48:51], s64 offen offset:3072 sc1 lds
    s_add_u32 m0, s59, 12288
    s_add_u32 s64, s62, 12288
    buffer_load_dwordx4 v2, s[48:51], s64 offen offset:0 sc1 lds
    buffer_load_dwordx4 v2, s[48:51], s64 offen offset:1024 sc1 lds
    buffer_load_dwordx4 v2, s[48:51], s64 offen offset:2048 sc1 lds
    buffer_load_dwordx4 v2, s[48:51], s64 offen offset:3072 sc1 lds
    s_barrier
    s_cmp_eq_u32 s3, 2
    s_cbranch_scc1 KVP_SKIP
    s_mov_b32 s59, 0x20207
    s_lshl_b32 s62, s3, 3
    s_lshr_b32 s59, s59, s62
    s_and_b32 s59, s59, 15
    s_add_u32 s62, s59, s94
    s_and_b32 s62, s62, 7
    s_lshl_b32 s62, s62, 14
    s_add_u32 s62, s62, 4194304
    s_lshl_b32 s59, s59, 14
    s_add_u32 m0, s59, 0
    s_add_u32 s64, s62, 0
    buffer_load_dwordx4 v2, s[48:51], s64 offen offset:0 sc1 lds
    buffer_load_dwordx4 v2, s[48:51], s64 offen offset:1024 sc1 lds
    buffer_load_dwordx4 v2, s[48:51], s64 offen offset:2048 sc1 lds
    buffer_load_dwordx4 v2, s[48:51], s64 offen offset:3072 sc1 lds
    s_add_u32 m0, s59, 4096
    s_add_u32 s64, s62, 4096
    buffer_load_dwordx4 v2, s[48:51], s64 offen offset:0 sc1 lds
    buffer_load_dwordx4 v2, s[48:51], s64 offen offset:1024 sc1 lds
    buffer_load_dwordx4 v2, s[48:51], s64 offen offset:2048 sc1 lds
    buffer_load_dwordx4 v2, s[48:51], s64 offen offset:3072 sc1 lds
    s_add_u32 m0, s59, 8192
    s_add_u32 s64, s62, 8192
    buffer_load_dwordx4 v2, s[48:51], s64 offen offset:0 sc1 lds
    buffer_load_dwordx4 v2, s[48:51], s64 offen offset:1024 sc1 lds
    buffer_load_dwordx4 v2, s[48:51], s64 offen offset:2048 sc1 lds
    buffer_load_dwordx4 v2, s[48:51], s64 offen offset:3072 sc1 lds
    s_add_u32 m0, s59, 12288
    s_add_u32 s64, s62, 12288
    buffer_load_dwordx4 v2, s[48:51], s64 offen offset:0 sc1 lds
    buffer_load_dwordx4 v2, s[48:51], s64 offen offset:1024 sc1 lds
    buffer_load_dwordx4 v2, s[48:51], s64 offen offset:2048 sc1 lds
    buffer_load_dwordx4 v2, s[48:51], s64 offen offset:3072 sc1 lds
KVP_SKIP:
    s_waitcnt vmcnt(0)
    s_barrier
    s_branch DOWN
SERVICE:
    v_lshrrev_b32 v7, 2, v1
    v_and_b32 v8, 3, v1
    v_lshlrev_b32 v8, 4, v8
    v_lshl_add_u32 v4, v7, 10, v8
    v_and_b32 v7, 32, v1
    v_xor_b32 v4, v4, v7
    s_lshl_b32 s63, s56, 6
    s_waitcnt lgkmcnt(0)
    s_mov_b32 s32, s6
    s_mov_b32 s33, s7
    s_mov_b32 s34, 524288
    s_mov_b32 s35, 0x00020000
    s_add_u32 s59, s58, 0
    s_and_b32 s59, s59, 7
    s_lshl_b32 s60, s59, 16
    s_add_u32 s60, s60, s63
    s_mov_b32 m0, 36864
    s_nop 0
    buffer_load_dwordx4 v4, s[32:35], s60 offen lds
    s_mov_b32 m0, 37888
    s_add_u32 s60, s60, 16384
    buffer_load_dwordx4 v4, s[32:35], s60 offen lds
    s_mov_b32 m0, 38912
    s_add_u32 s60, s60, 16384
    buffer_load_dwordx4 v4, s[32:35], s60 offen lds
    s_mov_b32 m0, 39936
    s_add_u32 s60, s60, 16384
    buffer_load_dwordx4 v4, s[32:35], s60 offen lds
    s_add_u32 s59, s58, 1
    s_and_b32 s59, s59, 7
    s_lshl_b32 s60, s59, 16
    s_add_u32 s60, s60, s63
    s_mov_b32 m0, 40960
    s_nop 0
    buffer_load_dwordx4 v4, s[32:35], s60 offen lds
    s_mov_b32 m0, 41984
    s_add_u32 s60, s60, 16384
    buffer_load_dwordx4 v4, s[32:35], s60 offen lds
    s_mov_b32 m0, 43008
    s_add_u32 s60, s60, 16384
    buffer_load_dwordx4 v4, s[32:35], s60 offen lds
    s_mov_b32 m0, 44032
    s_add_u32 s60, s60, 16384
    buffer_load_dwordx4 v4, s[32:35], s60 offen lds
    s_mov_b32 s48, s28
    s_mov_b32 s49, s29
    s_mov_b32 s50, 16777216
    s_mov_b32 s51, 0x00020000
    s_mov_b32 s72, s26
    s_mov_b32 s73, s27
    s_mov_b32 s74, 256
    s_mov_b32 s75, 0x00020000
    s_waitcnt vmcnt(4)
    s_barrier
    s_add_u32 s59, s58, 2
    s_and_b32 s59, s59, 7
    s_lshl_b32 s60, s59, 16
    s_add_u32 s60, s60, s63
    s_mov_b32 m0, 32768
    s_nop 0
    buffer_load_dwordx4 v4, s[32:35], s60 offen lds
    s_mov_b32 m0, 33792
    s_add_u32 s60, s60, 16384
    buffer_load_dwordx4 v4, s[32:35], s60 offen lds
    s_mov_b32 m0, 34816
    s_add_u32 s60, s60, 16384
    buffer_load_dwordx4 v4, s[32:35], s60 offen lds
    s_mov_b32 m0, 35840
    s_add_u32 s60, s60, 16384
    buffer_load_dwordx4 v4, s[32:35], s60 offen lds
    s_waitcnt vmcnt(4)
    s_barrier
    s_add_u32 s59, s58, 3
    s_and_b32 s59, s59, 7
    s_lshl_b32 s60, s59, 16
    s_add_u32 s60, s60, s63
    s_mov_b32 m0, 36864
    s_nop 0
    buffer_load_dwordx4 v4, s[32:35], s60 offen lds
    s_mov_b32 m0, 37888
    s_add_u32 s60, s60, 16384
    buffer_load_dwordx4 v4, s[32:35], s60 offen lds
    s_mov_b32 m0, 38912
    s_add_u32 s60, s60, 16384
    buffer_load_dwordx4 v4, s[32:35], s60 offen lds
    s_mov_b32 m0, 39936
    s_add_u32 s60, s60, 16384
    buffer_load_dwordx4 v4, s[32:35], s60 offen lds
    s_waitcnt vmcnt(4)
    s_barrier
    s_add_u32 s59, s58, 4
    s_and_b32 s59, s59, 7
    s_lshl_b32 s60, s59, 16
    s_add_u32 s60, s60, s63
    s_mov_b32 m0, 40960
    s_nop 0
    buffer_load_dwordx4 v4, s[32:35], s60 offen lds
    s_mov_b32 m0, 41984
    s_add_u32 s60, s60, 16384
    buffer_load_dwordx4 v4, s[32:35], s60 offen lds
    s_mov_b32 m0, 43008
    s_add_u32 s60, s60, 16384
    buffer_load_dwordx4 v4, s[32:35], s60 offen lds
    s_mov_b32 m0, 44032
    s_add_u32 s60, s60, 16384
    buffer_load_dwordx4 v4, s[32:35], s60 offen lds
    s_waitcnt vmcnt(4)
    s_barrier
    s_add_u32 s59, s58, 5
    s_and_b32 s59, s59, 7
    s_lshl_b32 s60, s59, 16
    s_add_u32 s60, s60, s63
    s_mov_b32 m0, 32768
    s_nop 0
    buffer_load_dwordx4 v4, s[32:35], s60 offen lds
    s_mov_b32 m0, 33792
    s_add_u32 s60, s60, 16384
    buffer_load_dwordx4 v4, s[32:35], s60 offen lds
    s_mov_b32 m0, 34816
    s_add_u32 s60, s60, 16384
    buffer_load_dwordx4 v4, s[32:35], s60 offen lds
    s_mov_b32 m0, 35840
    s_add_u32 s60, s60, 16384
    buffer_load_dwordx4 v4, s[32:35], s60 offen lds
    s_waitcnt vmcnt(4)
    s_barrier
    s_add_u32 s59, s58, 6
    s_and_b32 s59, s59, 7
    s_lshl_b32 s60, s59, 16
    s_add_u32 s60, s60, s63
    s_mov_b32 m0, 36864
    s_nop 0
    buffer_load_dwordx4 v4, s[32:35], s60 offen lds
    s_mov_b32 m0, 37888
    s_add_u32 s60, s60, 16384
    buffer_load_dwordx4 v4, s[32:35], s60 offen lds
    s_mov_b32 m0, 38912
    s_add_u32 s60, s60, 16384
    buffer_load_dwordx4 v4, s[32:35], s60 offen lds
    s_mov_b32 m0, 39936
    s_add_u32 s60, s60, 16384
    buffer_load_dwordx4 v4, s[32:35], s60 offen lds
    s_waitcnt vmcnt(4)
    s_barrier
    s_add_u32 s59, s58, 7
    s_and_b32 s59, s59, 7
    s_lshl_b32 s60, s59, 16
    s_add_u32 s60, s60, s63
    s_mov_b32 m0, 40960
    s_nop 0
    buffer_load_dwordx4 v4, s[32:35], s60 offen lds
    s_mov_b32 m0, 41984
    s_add_u32 s60, s60, 16384
    buffer_load_dwordx4 v4, s[32:35], s60 offen lds
    s_mov_b32 m0, 43008
    s_add_u32 s60, s60, 16384
    buffer_load_dwordx4 v4, s[32:35], s60 offen lds
    s_mov_b32 m0, 44032
    s_add_u32 s60, s60, 16384
    buffer_load_dwordx4 v4, s[32:35], s60 offen lds
    v_mov_b32 v17, 0
SPIN_1:
    buffer_load_dword v20, v17, s[72:75], 0 offen offset:128 sc1
SPINC_2:
    s_waitcnt vmcnt(0)
    v_cmp_eq_u32 vcc, 0, v20
    s_nop 4
    s_cbranch_vccz SPIND_3
    s_cmp_eq_u32 s100, 0
    s_cbranch_scc1 SPIND_3
    s_sub_u32 s100, s100, 1
    s_sleep 4
    s_branch SPIN_1
SPIND_3:
    s_barrier
    s_barrier
    s_barrier
    v_mov_b32 v17, 0
SPIN_4:
    buffer_load_dword v20, v17, s[72:75], 0 offen offset:192 sc1
SPINC_5:
    s_waitcnt vmcnt(0)
    v_cmp_eq_u32 vcc, 0, v20
    s_nop 4
    s_cbranch_vccz SPIND_6
    s_cmp_eq_u32 s100, 0
    s_cbranch_scc1 SPIND_6
    s_sub_u32 s100, s100, 1
    s_sleep 4
    s_branch SPIN_4
SPIND_6:
    s_barrier
DOWN:
    s_mov_b32 s44, s20
    s_mov_b32 s45, s21
    s_mov_b32 s46, 1835008
    s_mov_b32 s47, 0x00020000
    s_mul_i32 s32, s76, 224
    s_mul_i32 s60, s3, 28
    s_add_u32 s32, s32, s60
    s_lshl_b32 s32, s32, 10
    s_add_u32 s32, s32, 8388608
    s_add_u32 s33, s32, 114688
    s_lshl_b32 s36, s60, 14
    s_lshl_b32 s61, s77, 7
    s_add_u32 s36, s36, s61
    s_mul_i32 s37, s3, 8192
    s_add_u32 s37, s37, 131072
    s_setprio 3
    v_lshrrev_b32 v7, 3, v1
    v_bfe_u32 v8, v1, 4, 1
    v_lshlrev_b32 v8, 2, v8
    v_and_b32 v4, 7, v1
    v_xor_b32 v4, v4, v8
    v_lshlrev_b32 v4, 4, v4
    v_lshl_add_u32 v4, v7, 10, v4
    v_bfe_u32 v7, v1, 2, 2
    v_lshrrev_b32 v8, 5, v1
    v_lshl_add_u32 v9, v8, 2, v7
    v_lshlrev_b32 v9, 7, v9
    v_bfe_u32 v8, v1, 4, 1
    v_lshl_add_u32 v9, v8, 5, v9
    v_and_b32 v8, 3, v1
    v_lshl_add_u32 v9, v8, 3, v9
    v_bfe_u32 v8, v1, 3, 1
    v_lshlrev_b32 v8, 6, v8
    v_add_u32 v9, v9, v8
    v_xor_b32 v10, 64, v9
    v_add_u32 v9, s37, v9
    v_add_u32 v10, s37, v10
    s_lshl_b32 s62, s76, 9
    s_lshl_b32 s60, s3, 7
    s_add_u32 s62, s62, s60
    s_add_u32 s62, s62, 4337664
    s_mov_b32 s40, s12
    s_mov_b32 s41, s13
    s_mov_b32 s42, 524288
    s_mov_b32 s43, 0x00020000
    s_lshl_b32 s38, s3, 17
    s_add_u32 s38, s38, s61
    s_lshl_b32 s39, s95, 1
    s_add_u32 s39, s39, s94
    s_cmp_ge_u32 s39, 7
    s_cselect_b32 s60, 7, 0
    s_sub_u32 s39, s39, s60
    s_cmp_ge_u32 s56, 14
    s_cbranch_scc1 H_SKIP
    v_add_u32 v7, s37, v2
    ds_read_b128 v[104:107], v7 offset:0
    ds_read_b128 v[108:111], v7 offset:1024
    ds_read_b128 v[112:115], v7 offset:2048
    ds_read_b128 v[116:119], v7 offset:3072
    ds_read_b128 v[120:123], v7 offset:4096
    ds_read_b128 v[124:127], v7 offset:5120
    ds_read_b128 v[128:131], v7 offset:6144
    ds_read_b128 v[132:135], v7 offset:7168
    s_lshl_b32 s64, s31, 2
    s_and_b32 s60, s3, 2
    s_add_u32 s64, s64, s60
    s_mul_i32 s64, s64, 112
    s_lshl_b32 s60, s56, 1
    s_and_b32 s61, s3, 1
    s_add_u32 s66, s60, s61
    s_lshl_b32 s60, s66, 2
    s_add_u32 s64, s64, s60
    s_lshl_b32 s64, s64, 10
    s_add_u32 s64, s64, 8388608
    s_add_u32 s65, s64, 114688
    s_mul_i32 s60, s66, 37
    s_lshr_b32 s60, s60, 8
    s_mul_i32 s61, s60, 25
    s_add_u32 s66, s66, s61
    s_lshl_b32 s66, s66, 2
    s_lshl_b32 s60, s31, 10
    s_add_u32 s66, s66, s60
    s_and_b32 s60, s3, 2
    s_lshl_b32 s60, s60, 8
    s_add_u32 s66, s66, s60
    s_add_u32 s66, s66, 4337664
    s_waitcnt lgkmcnt(0)
    buffer_store_dwordx4 v[104:107], v2, s[48:51], s64 offen offset:0 sc1
    buffer_store_dwordx4 v[108:111], v2, s[48:51], s64 offen offset:1024 sc1
    buffer_store_dwordx4 v[112:115], v2, s[48:51], s65 offen offset:0 sc1
    buffer_store_dwordx4 v[116:119], v2, s[48:51], s65 offen offset:1024 sc1
    buffer_store_dwordx4 v[120:123], v2, s[48:51], s64 offen offset:2048 sc1
    buffer_store_dwordx4 v[124:127], v2, s[48:51], s64 offen offset:3072 sc1
    buffer_store_dwordx4 v[128:131], v2, s[48:51], s65 offen offset:2048 sc1
    buffer_store_dwordx4 v[132:135], v2, s[48:51], s65 offen offset:3072 sc1
    v_mov_b32 v12, 1
    v_mov_b32 v11, 0
    s_waitcnt vmcnt(0)
    s_mov_b64 exec, 1
    buffer_store_dword v12, v11, s[48:51], s66 offen sc1
    s_mov_b64 exec, -1
H_SKIP:
    s_add_u32 m0, s37, 0
    s_add_u32 s60, s38, 0
    buffer_load_dwordx4 v4, s[40:43], s60 offen lds
    s_add_u32 m0, s37, 1024
    s_add_u32 s60, s38, 8192
    buffer_load_dwordx4 v4, s[40:43], s60 offen lds
    s_add_u32 m0, s37, 2048
    s_add_u32 s60, s38, 32768
    buffer_load_dwordx4 v4, s[40:43], s60 offen lds
    s_add_u32 m0, s37, 3072
    s_add_u32 s60, s38, 40960
    buffer_load_dwordx4 v4, s[40:43], s60 offen lds
    s_add_u32 m0, s37, 4096
    s_add_u32 s60, s38, 65536
    buffer_load_dwordx4 v4, s[40:43], s60 offen lds
    s_add_u32 m0, s37, 5120
    s_add_u32 s60, s38, 73728
    buffer_load_dwordx4 v4, s[40:43], s60 offen lds
    s_add_u32 m0, s37, 6144
    s_add_u32 s60, s38, 98304
    buffer_load_dwordx4 v4, s[40:43], s60 offen lds
    s_add_u32 m0, s37, 7168
    s_add_u32 s60, s38, 106496
    buffer_load_dwordx4 v4, s[40:43], s60 offen lds
    v_and_b32 v7, 31, v1
    v_lshlrev_b32 v7, 2, v7
    s_lshl_b32 s60, s76, 8
    s_add_u32 s60, s60, 4329472
    buffer_load_dword v14, v7, s[48:51], s60 offen sc1
    buffer_load_dword v16, v7, s[48:51], s60 offen offset:128 sc1
    s_waitcnt vmcnt(0)
    ds_read_b64_tr_b16 v[136:137], v9 offset:0
    ds_read_b64_tr_b16 v[138:139], v9 offset:1024
    ds_read_b64_tr_b16 v[140:141], v10 offset:0
    ds_read_b64_tr_b16 v[142:143], v10 offset:1024
    ds_read_b64_tr_b16 v[144:145], v9 offset:2048
    ds_read_b64_tr_b16 v[146:147], v9 offset:3072
    ds_read_b64_tr_b16 v[148:149], v10 offset:2048
    ds_read_b64_tr_b16 v[150:151], v10 offset:3072
    ds_read_b64_tr_b16 v[152:153], v9 offset:4096
    ds_read_b64_tr_b16 v[154:155], v9 offset:5120
    ds_read_b64_tr_b16 v[156:157], v10 offset:4096
    ds_read_b64_tr_b16 v[158:159], v10 offset:5120
    ds_read_b64_tr_b16 v[160:161], v9 offset:6144
    ds_read_b64_tr_b16 v[162:163], v9 offset:7168
    ds_read_b64_tr_b16 v[164:165], v10 offset:6144
    ds_read_b64_tr_b16 v[166:167], v10 offset:7168
    v_sub_f32 v14, 1.0, v14
    v_sub_f32 v16, 1.0, v16
    v_mov_b32 v15, v14
    v_mov_b32 v17, v16
    s_waitcnt lgkmcnt(0)
    s_lshl_b32 s67, s39, 16
    s_add_u32 s67, s67, s36
    s_add_u32 m0, s37, 0
    s_add_u32 s60, s67, 0
    buffer_load_dwordx4 v4, s[44:47], s60 offen lds
    s_add_u32 m0, s37, 1024
    s_add_u32 s60, s67, 8192
    buffer_load_dwordx4 v4, s[44:47], s60 offen lds
    s_add_u32 m0, s37, 2048
    s_add_u32 s60, s67, 16384
    buffer_load_dwordx4 v4, s[44:47], s60 offen lds
    s_add_u32 m0, s37, 3072
    s_add_u32 s60, s67, 24576
    buffer_load_dwordx4 v4, s[44:47], s60 offen lds
    s_add_u32 m0, s37, 4096
    s_add_u32 s60, s67, 32768
    buffer_load_dwordx4 v4, s[44:47], s60 offen lds
    s_add_u32 m0, s37, 5120
    s_add_u32 s60, s67, 40960
    buffer_load_dwordx4 v4, s[44:47], s60 offen lds
    s_add_u32 m0, s37, 6144
    s_add_u32 s60, s67, 49152
    buffer_load_dwordx4 v4, s[44:47], s60 offen lds
    s_add_u32 m0, s37, 7168
    s_add_u32 s60, s67, 57344
    buffer_load_dwordx4 v4, s[44:47], s60 offen lds
SPIN_7:
    s_mov_b64 exec, 0x7f
    buffer_load_dword v20, v3, s[48:51], s62 offen sc1
    s_mov_b64 exec, -1
SPINC_8:
    s_waitcnt vmcnt(0)
    s_mov_b64 exec, 0x7f
    v_cmp_ne_u32 vcc, 1, v20
    s_mov_b64 exec, -1
    s_nop 4
    s_cbranch_vccz SPIND_9
    s_cmp_eq_u32 s100, 0
    s_cbranch_scc1 SPIND_9
    s_sub_u32 s100, s100, 1
    s_sleep 16
    s_branch SPIN_7
SPIND_9:
    s_setprio 0
    s_lshl_b32 s60, s39, 12
    s_add_u32 s68, s60, s32
    s_add_u32 s69, s60, s33
    s_add_u32 s39, s39, 1
    s_cmp_eq_u32 s39, 7
    s_cselect_b32 s39, 0, s39
    buffer_load_dwordx4 v[104:107], v2, s[48:51], s68 offen offset:0 sc1
    buffer_load_dwordx4 v[108:111], v2, s[48:51], s69 offen offset:0 sc1
    buffer_load_dwordx4 v[112:115], v2, s[48:51], s68 offen offset:1024 sc1
    buffer_load_dwordx4 v[116:119], v2, s[48:51], s69 offen offset:1024 sc1
    buffer_load_dwordx4 v[120:123], v2, s[48:51], s68 offen offset:2048 sc1
    buffer_load_dwordx4 v[124:127], v2, s[48:51], s69 offen offset:2048 sc1
    buffer_load_dwordx4 v[128:131], v2, s[48:51], s68 offen offset:3072 sc1
    buffer_load_dwordx4 v[132:135], v2, s[48:51], s69 offen offset:3072 sc1
    ds_read_b64_tr_b16 v[88:89], v9 offset:0
    ds_read_b64_tr_b16 v[90:91], v9 offset:1024
    ds_read_b64_tr_b16 v[92:93], v10 offset:0
    ds_read_b64_tr_b16 v[94:95], v10 offset:1024
    s_waitcnt lgkmcnt(0)
    s_lshl_b32 s67, s39, 16
    s_add_u32 s67, s67, s36
    s_lshl_b32 s60, s39, 12
    s_add_u32 s68, s60, s32
    s_add_u32 s69, s60, s33
    s_add_u32 s39, s39, 1
    s_cmp_eq_u32 s39, 7
    s_cselect_b32 s39, 0, s39
    s_add_u32 m0, s37, 0
    s_add_u32 s60, s67, 0
    buffer_load_dwordx4 v4, s[44:47], s60 offen lds
    s_add_u32 m0, s37, 1024
    s_add_u32 s60, s67, 8192
    buffer_load_dwordx4 v4, s[44:47], s60 offen lds
    ds_read_b64_tr_b16 v[96:97], v9 offset:2048
    ds_read_b64_tr_b16 v[98:99], v9 offset:3072
    ds_read_b64_tr_b16 v[100:101], v10 offset:2048
    ds_read_b64_tr_b16 v[102:103], v10 offset:3072
    s_waitcnt vmcnt(8)
    v_mfma_f32_32x32x16_bf16 v[24:39], v[88:91], v[104:107], 0
    v_mfma_f32_32x32x16_bf16 v[40:55], v[88:91], v[108:111], 0
    v_mfma_f32_32x32x16_bf16 v[72:87], v[92:95], v[108:111], 0
    v_mfma_f32_32x32x16_bf16 v[56:71], v[92:95], v[104:107], 0
    buffer_load_dwordx4 v[104:107], v2, s[48:51], s68 offen offset:0 sc1
    buffer_load_dwordx4 v[108:111], v2, s[48:51], s69 offen offset:0 sc1
    s_waitcnt lgkmcnt(0)
    s_add_u32 m0, s37, 2048
    s_add_u32 s60, s67, 16384
    buffer_load_dwordx4 v4, s[44:47], s60 offen lds
    s_add_u32 m0, s37, 3072
    s_add_u32 s60, s67, 24576
    buffer_load_dwordx4 v4, s[44:47], s60 offen lds
    ds_read_b64_tr_b16 v[88:89], v9 offset:4096
    ds_read_b64_tr_b16 v[90:91], v9 offset:5120
    ds_read_b64_tr_b16 v[92:93], v10 offset:4096
    ds_read_b64_tr_b16 v[94:95], v10 offset:5120
    s_waitcnt vmcnt(10)
    v_mfma_f32_32x32x16_bf16 v[24:39], v[96:99], v[112:115], v[24:39]
    v_mfma_f32_32x32x16_bf16 v[40:55], v[96:99], v[116:119], v[40:55]
    v_mfma_f32_32x32x16_bf16 v[72:87], v[100:103], v[116:119], v[72:87]
    v_mfma_f32_32x32x16_bf16 v[56:71], v[100:103], v[112:115], v[56:71]
    buffer_load_dwordx4 v[112:115], v2, s[48:51], s68 offen offset:1024 sc1
    buffer_load_dwordx4 v[116:119], v2, s[48:51], s69 offen offset:1024 sc1
    s_waitcnt lgkmcnt(0)
    s_add_u32 m0, s37, 4096
    s_add_u32 s60, s67, 32768
    buffer_load_dwordx4 v4, s[44:47], s60 offen lds
    s_add_u32 m0, s37, 5120
    s_add_u32 s60, s67, 40960
    buffer_load_dwordx4 v4, s[44:47], s60 offen lds
    ds_read_b64_tr_b16 v[96:97], v9 offset:6144
    ds_read_b64_tr_b16 v[98:99], v9 offset:7168
    ds_read_b64_tr_b16 v[100:101], v10 offset:6144
    ds_read_b64_tr_b16 v[102:103], v10 offset:7168
    s_waitcnt vmcnt(12)
    v_mfma_f32_32x32x16_bf16 v[24:39], v[88:91], v[120:123], v[24:39]
    v_mfma_f32_32x32x16_bf16 v[40:55], v[88:91], v[124:127], v[40:55]
    v_mfma_f32_32x32x16_bf16 v[72:87], v[92:95], v[124:127], v[72:87]
    v_mfma_f32_32x32x16_bf16 v[56:71], v[92:95], v[120:123], v[56:71]
    buffer_load_dwordx4 v[120:123], v2, s[48:51], s68 offen offset:2048 sc1
    buffer_load_dwordx4 v[124:127], v2, s[48:51], s69 offen offset:2048 sc1
    s_waitcnt lgkmcnt(0)
    s_add_u32 m0, s37, 6144
    s_add_u32 s60, s67, 49152
    buffer_load_dwordx4 v4, s[44:47], s60 offen lds
    s_add_u32 m0, s37, 7168
    s_add_u32 s60, s67, 57344
    buffer_load_dwordx4 v4, s[44:47], s60 offen lds
    s_waitcnt vmcnt(12)
    ds_read_b64_tr_b16 v[88:89], v9 offset:0
    ds_read_b64_tr_b16 v[90:91], v9 offset:1024
    ds_read_b64_tr_b16 v[92:93], v10 offset:0
    ds_read_b64_tr_b16 v[94:95], v10 offset:1024
    v_mfma_f32_32x32x16_bf16 v[24:39], v[96:99], v[128:131], v[24:39]
    v_mfma_f32_32x32x16_bf16 v[40:55], v[96:99], v[132:135], v[40:55]
    v_mfma_f32_32x32x16_bf16 v[72:87], v[100:103], v[132:135], v[72:87]
    v_mfma_f32_32x32x16_bf16 v[56:71], v[100:103], v[128:131], v[56:71]
    buffer_load_dwordx4 v[128:131], v2, s[48:51], s68 offen offset:3072 sc1
    buffer_load_dwordx4 v[132:135], v2, s[48:51], s69 offen offset:3072 sc1
    s_waitcnt lgkmcnt(0)
    s_lshl_b32 s67, s39, 16
    s_add_u32 s67, s67, s36
    s_lshl_b32 s60, s39, 12
    s_add_u32 s68, s60, s32
    s_add_u32 s69, s60, s33
    s_add_u32 s39, s39, 1
    s_cmp_eq_u32 s39, 7
    s_cselect_b32 s39, 0, s39
    s_add_u32 m0, s37, 0
    s_add_u32 s60, s67, 0
    buffer_load_dwordx4 v4, s[44:47], s60 offen lds
    s_add_u32 m0, s37, 1024
    s_add_u32 s60, s67, 8192
    buffer_load_dwordx4 v4, s[44:47], s60 offen lds
    s_waitcnt vmcnt(12)
    ds_read_b64_tr_b16 v[96:97], v9 offset:2048
    ds_read_b64_tr_b16 v[98:99], v9 offset:3072
    ds_read_b64_tr_b16 v[100:101], v10 offset:2048
    ds_read_b64_tr_b16 v[102:103], v10 offset:3072
    v_mfma_f32_32x32x16_bf16 v[24:39], v[88:91], v[104:107], v[24:39]
    v_mfma_f32_32x32x16_bf16 v[40:55], v[88:91], v[108:111], v[40:55]
    v_mfma_f32_32x32x16_bf16 v[72:87], v[92:95], v[108:111], v[72:87]
    v_mfma_f32_32x32x16_bf16 v[56:71], v[92:95], v[104:107], v[56:71]
    buffer_load_dwordx4 v[104:107], v2, s[48:51], s68 offen offset:0 sc1
    buffer_load_dwordx4 v[108:111], v2, s[48:51], s69 offen offset:0 sc1
    s_waitcnt lgkmcnt(0)
    s_add_u32 m0, s37, 2048
    s_add_u32 s60, s67, 16384
    buffer_load_dwordx4 v4, s[44:47], s60 offen lds
    s_add_u32 m0, s37, 3072
    s_add_u32 s60, s67, 24576
    buffer_load_dwordx4 v4, s[44:47], s60 offen lds
    s_waitcnt vmcnt(12)
    ds_read_b64_tr_b16 v[88:89], v9 offset:4096
    ds_read_b64_tr_b16 v[90:91], v9 offset:5120
    ds_read_b64_tr_b16 v[92:93], v10 offset:4096
    ds_read_b64_tr_b16 v[94:95], v10 offset:5120
    v_mfma_f32_32x32x16_bf16 v[24:39], v[96:99], v[112:115], v[24:39]
    v_mfma_f32_32x32x16_bf16 v[40:55], v[96:99], v[116:119], v[40:55]
    v_mfma_f32_32x32x16_bf16 v[72:87], v[100:103], v[116:119], v[72:87]
    v_mfma_f32_32x32x16_bf16 v[56:71], v[100:103], v[112:115], v[56:71]
    buffer_load_dwordx4 v[112:115], v2, s[48:51], s68 offen offset:1024 sc1
    buffer_load_dwordx4 v[116:119], v2, s[48:51], s69 offen offset:1024 sc1
    s_waitcnt lgkmcnt(0)
    s_add_u32 m0, s37, 4096
    s_add_u32 s60, s67, 32768
    buffer_load_dwordx4 v4, s[44:47], s60 offen lds
    s_add_u32 m0, s37, 5120
    s_add_u32 s60, s67, 40960
    buffer_load_dwordx4 v4, s[44:47], s60 offen lds
    s_waitcnt vmcnt(12)
    ds_read_b64_tr_b16 v[96:97], v9 offset:6144
    ds_read_b64_tr_b16 v[98:99], v9 offset:7168
    ds_read_b64_tr_b16 v[100:101], v10 offset:6144
    ds_read_b64_tr_b16 v[102:103], v10 offset:7168
    v_mfma_f32_32x32x16_bf16 v[24:39], v[88:91], v[120:123], v[24:39]
    v_mfma_f32_32x32x16_bf16 v[40:55], v[88:91], v[124:127], v[40:55]
    v_mfma_f32_32x32x16_bf16 v[72:87], v[92:95], v[124:127], v[72:87]
    v_mfma_f32_32x32x16_bf16 v[56:71], v[92:95], v[120:123], v[56:71]
    buffer_load_dwordx4 v[120:123], v2, s[48:51], s68 offen offset:2048 sc1
    buffer_load_dwordx4 v[124:127], v2, s[48:51], s69 offen offset:2048 sc1
    s_waitcnt lgkmcnt(0)
    s_add_u32 m0, s37, 6144
    s_add_u32 s60, s67, 49152
    buffer_load_dwordx4 v4, s[44:47], s60 offen lds
    s_add_u32 m0, s37, 7168
    s_add_u32 s60, s67, 57344
    buffer_load_dwordx4 v4, s[44:47], s60 offen lds
    s_waitcnt vmcnt(12)
    ds_read_b64_tr_b16 v[88:89], v9 offset:0
    ds_read_b64_tr_b16 v[90:91], v9 offset:1024
    ds_read_b64_tr_b16 v[92:93], v10 offset:0
    ds_read_b64_tr_b16 v[94:95], v10 offset:1024
    v_mfma_f32_32x32x16_bf16 v[24:39], v[96:99], v[128:131], v[24:39]
    v_mfma_f32_32x32x16_bf16 v[40:55], v[96:99], v[132:135], v[40:55]
    v_mfma_f32_32x32x16_bf16 v[72:87], v[100:103], v[132:135], v[72:87]
    v_mfma_f32_32x32x16_bf16 v[56:71], v[100:103], v[128:131], v[56:71]
    buffer_load_dwordx4 v[128:131], v2, s[48:51], s68 offen offset:3072 sc1
    buffer_load_dwordx4 v[132:135], v2, s[48:51], s69 offen offset:3072 sc1
    s_waitcnt lgkmcnt(0)
    s_lshl_b32 s67, s39, 16
    s_add_u32 s67, s67, s36
    s_lshl_b32 s60, s39, 12
    s_add_u32 s68, s60, s32
    s_add_u32 s69, s60, s33
    s_add_u32 s39, s39, 1
    s_cmp_eq_u32 s39, 7
    s_cselect_b32 s39, 0, s39
    s_add_u32 m0, s37, 0
    s_add_u32 s60, s67, 0
    buffer_load_dwordx4 v4, s[44:47], s60 offen lds
    s_add_u32 m0, s37, 1024
    s_add_u32 s60, s67, 8192
    buffer_load_dwordx4 v4, s[44:47], s60 offen lds
    s_waitcnt vmcnt(12)
    ds_read_b64_tr_b16 v[96:97], v9 offset:2048
    ds_read_b64_tr_b16 v[98:99], v9 offset:3072
    ds_read_b64_tr_b16 v[100:101], v10 offset:2048
    ds_read_b64_tr_b16 v[102:103], v10 offset:3072
    v_mfma_f32_32x32x16_bf16 v[24:39], v[88:91], v[104:107], v[24:39]
    v_mfma_f32_32x32x16_bf16 v[40:55], v[88:91], v[108:111], v[40:55]
    v_mfma_f32_32x32x16_bf16 v[72:87], v[92:95], v[108:111], v[72:87]
    v_mfma_f32_32x32x16_bf16 v[56:71], v[92:95], v[104:107], v[56:71]
    buffer_load_dwordx4 v[104:107], v2, s[48:51], s68 offen offset:0 sc1
    buffer_load_dwordx4 v[108:111], v2, s[48:51], s69 offen offset:0 sc1
    s_waitcnt lgkmcnt(0)
    s_add_u32 m0, s37, 2048
    s_add_u32 s60, s67, 16384
    buffer_load_dwordx4 v4, s[44:47], s60 offen lds
    s_add_u32 m0, s37, 3072
    s_add_u32 s60, s67, 24576
    buffer_load_dwordx4 v4, s[44:47], s60 offen lds
    s_waitcnt vmcnt(12)
    ds_read_b64_tr_b16 v[88:89], v9 offset:4096
    ds_read_b64_tr_b16 v[90:91], v9 offset:5120
    ds_read_b64_tr_b16 v[92:93], v10 offset:4096
    ds_read_b64_tr_b16 v[94:95], v10 offset:5120
    v_mfma_f32_32x32x16_bf16 v[24:39], v[96:99], v[112:115], v[24:39]
    v_mfma_f32_32x32x16_bf16 v[40:55], v[96:99], v[116:119], v[40:55]
    v_mfma_f32_32x32x16_bf16 v[72:87], v[100:103], v[116:119], v[72:87]
    v_mfma_f32_32x32x16_bf16 v[56:71], v[100:103], v[112:115], v[56:71]
    buffer_load_dwordx4 v[112:115], v2, s[48:51], s68 offen offset:1024 sc1
    buffer_load_dwordx4 v[116:119], v2, s[48:51], s69 offen offset:1024 sc1
    s_waitcnt lgkmcnt(0)
    s_add_u32 m0, s37, 4096
    s_add_u32 s60, s67, 32768
    buffer_load_dwordx4 v4, s[44:47], s60 offen lds
    s_add_u32 m0, s37, 5120
    s_add_u32 s60, s67, 40960
    buffer_load_dwordx4 v4, s[44:47], s60 offen lds
    s_waitcnt vmcnt(12)
    ds_read_b64_tr_b16 v[96:97], v9 offset:6144
    ds_read_b64_tr_b16 v[98:99], v9 offset:7168
    ds_read_b64_tr_b16 v[100:101], v10 offset:6144
    ds_read_b64_tr_b16 v[102:103], v10 offset:7168
    v_mfma_f32_32x32x16_bf16 v[24:39], v[88:91], v[120:123], v[24:39]
    v_mfma_f32_32x32x16_bf16 v[40:55], v[88:91], v[124:127], v[40:55]
    v_mfma_f32_32x32x16_bf16 v[72:87], v[92:95], v[124:127], v[72:87]
    v_mfma_f32_32x32x16_bf16 v[56:71], v[92:95], v[120:123], v[56:71]
    buffer_load_dwordx4 v[120:123], v2, s[48:51], s68 offen offset:2048 sc1
    buffer_load_dwordx4 v[124:127], v2, s[48:51], s69 offen offset:2048 sc1
    s_waitcnt lgkmcnt(0)
    s_add_u32 m0, s37, 6144
    s_add_u32 s60, s67, 49152
    buffer_load_dwordx4 v4, s[44:47], s60 offen lds
    s_add_u32 m0, s37, 7168
    s_add_u32 s60, s67, 57344
    buffer_load_dwordx4 v4, s[44:47], s60 offen lds
    s_waitcnt vmcnt(12)
    ds_read_b64_tr_b16 v[88:89], v9 offset:0
    ds_read_b64_tr_b16 v[90:91], v9 offset:1024
    ds_read_b64_tr_b16 v[92:93], v10 offset:0
    ds_read_b64_tr_b16 v[94:95], v10 offset:1024
    v_mfma_f32_32x32x16_bf16 v[24:39], v[96:99], v[128:131], v[24:39]
    v_mfma_f32_32x32x16_bf16 v[40:55], v[96:99], v[132:135], v[40:55]
    v_mfma_f32_32x32x16_bf16 v[72:87], v[100:103], v[132:135], v[72:87]
    v_mfma_f32_32x32x16_bf16 v[56:71], v[100:103], v[128:131], v[56:71]
    buffer_load_dwordx4 v[128:131], v2, s[48:51], s68 offen offset:3072 sc1
    buffer_load_dwordx4 v[132:135], v2, s[48:51], s69 offen offset:3072 sc1
    s_waitcnt lgkmcnt(0)
    s_lshl_b32 s67, s39, 16
    s_add_u32 s67, s67, s36
    s_lshl_b32 s60, s39, 12
    s_add_u32 s68, s60, s32
    s_add_u32 s69, s60, s33
    s_add_u32 s39, s39, 1
    s_cmp_eq_u32 s39, 7
    s_cselect_b32 s39, 0, s39
    s_add_u32 m0, s37, 0
    s_add_u32 s60, s67, 0
    buffer_load_dwordx4 v4, s[44:47], s60 offen lds
    s_add_u32 m0, s37, 1024
    s_add_u32 s60, s67, 8192
    buffer_load_dwordx4 v4, s[44:47], s60 offen lds
    s_waitcnt vmcnt(12)
    ds_read_b64_tr_b16 v[96:97], v9 offset:2048
    ds_read_b64_tr_b16 v[98:99], v9 offset:3072
    ds_read_b64_tr_b16 v[100:101], v10 offset:2048
    ds_read_b64_tr_b16 v[102:103], v10 offset:3072
    v_mfma_f32_32x32x16_bf16 v[24:39], v[88:91], v[104:107], v[24:39]
    v_mfma_f32_32x32x16_bf16 v[40:55], v[88:91], v[108:111], v[40:55]
    v_mfma_f32_32x32x16_bf16 v[72:87], v[92:95], v[108:111], v[72:87]
    v_mfma_f32_32x32x16_bf16 v[56:71], v[92:95], v[104:107], v[56:71]
    buffer_load_dwordx4 v[104:107], v2, s[48:51], s68 offen offset:0 sc1
    buffer_load_dwordx4 v[108:111], v2, s[48:51], s69 offen offset:0 sc1
    s_waitcnt lgkmcnt(0)
    s_add_u32 m0, s37, 2048
    s_add_u32 s60, s67, 16384
    buffer_load_dwordx4 v4, s[44:47], s60 offen lds
    s_add_u32 m0, s37, 3072
    s_add_u32 s60, s67, 24576
    buffer_load_dwordx4 v4, s[44:47], s60 offen lds
    s_waitcnt vmcnt(12)
    ds_read_b64_tr_b16 v[88:89], v9 offset:4096
    ds_read_b64_tr_b16 v[90:91], v9 offset:5120
    ds_read_b64_tr_b16 v[92:93], v10 offset:4096
    ds_read_b64_tr_b16 v[94:95], v10 offset:5120
    v_mfma_f32_32x32x16_bf16 v[24:39], v[96:99], v[112:115], v[24:39]
    v_mfma_f32_32x32x16_bf16 v[40:55], v[96:99], v[116:119], v[40:55]
    v_mfma_f32_32x32x16_bf16 v[72:87], v[100:103], v[116:119], v[72:87]
    v_mfma_f32_32x32x16_bf16 v[56:71], v[100:103], v[112:115], v[56:71]
    buffer_load_dwordx4 v[112:115], v2, s[48:51], s68 offen offset:1024 sc1
    buffer_load_dwordx4 v[116:119], v2, s[48:51], s69 offen offset:1024 sc1
    s_waitcnt lgkmcnt(0)
    s_add_u32 m0, s37, 4096
    s_add_u32 s60, s67, 32768
    buffer_load_dwordx4 v4, s[44:47], s60 offen lds
    s_add_u32 m0, s37, 5120
    s_add_u32 s60, s67, 40960
    buffer_load_dwordx4 v4, s[44:47], s60 offen lds
    s_waitcnt vmcnt(12)
    ds_read_b64_tr_b16 v[96:97], v9 offset:6144
    ds_read_b64_tr_b16 v[98:99], v9 offset:7168
    ds_read_b64_tr_b16 v[100:101], v10 offset:6144
    ds_read_b64_tr_b16 v[102:103], v10 offset:7168
    v_mfma_f32_32x32x16_bf16 v[24:39], v[88:91], v[120:123], v[24:39]
    v_mfma_f32_32x32x16_bf16 v[40:55], v[88:91], v[124:127], v[40:55]
    v_mfma_f32_32x32x16_bf16 v[72:87], v[92:95], v[124:127], v[72:87]
    v_mfma_f32_32x32x16_bf16 v[56:71], v[92:95], v[120:123], v[56:71]
    buffer_load_dwordx4 v[120:123], v2, s[48:51], s68 offen offset:2048 sc1
    buffer_load_dwordx4 v[124:127], v2, s[48:51], s69 offen offset:2048 sc1
    s_waitcnt lgkmcnt(0)
    s_add_u32 m0, s37, 6144
    s_add_u32 s60, s67, 49152
    buffer_load_dwordx4 v4, s[44:47], s60 offen lds
    s_add_u32 m0, s37, 7168
    s_add_u32 s60, s67, 57344
    buffer_load_dwordx4 v4, s[44:47], s60 offen lds
    s_waitcnt vmcnt(12)
    ds_read_b64_tr_b16 v[88:89], v9 offset:0
    ds_read_b64_tr_b16 v[90:91], v9 offset:1024
    ds_read_b64_tr_b16 v[92:93], v10 offset:0
    ds_read_b64_tr_b16 v[94:95], v10 offset:1024
    v_mfma_f32_32x32x16_bf16 v[24:39], v[96:99], v[128:131], v[24:39]
    v_mfma_f32_32x32x16_bf16 v[40:55], v[96:99], v[132:135], v[40:55]
    v_mfma_f32_32x32x16_bf16 v[72:87], v[100:103], v[132:135], v[72:87]
    v_mfma_f32_32x32x16_bf16 v[56:71], v[100:103], v[128:131], v[56:71]
    buffer_load_dwordx4 v[128:131], v2, s[48:51], s68 offen offset:3072 sc1
    buffer_load_dwordx4 v[132:135], v2, s[48:51], s69 offen offset:3072 sc1
    s_waitcnt lgkmcnt(0)
    s_lshl_b32 s67, s39, 16
    s_add_u32 s67, s67, s36
    s_lshl_b32 s60, s39, 12
    s_add_u32 s68, s60, s32
    s_add_u32 s69, s60, s33
    s_add_u32 s39, s39, 1
    s_cmp_eq_u32 s39, 7
    s_cselect_b32 s39, 0, s39
    s_add_u32 m0, s37, 0
    s_add_u32 s60, s67, 0
    buffer_load_dwordx4 v4, s[44:47], s60 offen lds
    s_add_u32 m0, s37, 1024
    s_add_u32 s60, s67, 8192
    buffer_load_dwordx4 v4, s[44:47], s60 offen lds
    s_waitcnt vmcnt(12)
    ds_read_b64_tr_b16 v[96:97], v9 offset:2048
    ds_read_b64_tr_b16 v[98:99], v9 offset:3072
    ds_read_b64_tr_b16 v[100:101], v10 offset:2048
    ds_read_b64_tr_b16 v[102:103], v10 offset:3072
    v_mfma_f32_32x32x16_bf16 v[24:39], v[88:91], v[104:107], v[24:39]
    v_mfma_f32_32x32x16_bf16 v[40:55], v[88:91], v[108:111], v[40:55]
    v_mfma_f32_32x32x16_bf16 v[72:87], v[92:95], v[108:111], v[72:87]
    v_mfma_f32_32x32x16_bf16 v[56:71], v[92:95], v[104:107], v[56:71]
    buffer_load_dwordx4 v[104:107], v2, s[48:51], s68 offen offset:0 sc1
    buffer_load_dwordx4 v[108:111], v2, s[48:51], s69 offen offset:0 sc1
    s_waitcnt lgkmcnt(0)
    s_add_u32 m0, s37, 2048
    s_add_u32 s60, s67, 16384
    buffer_load_dwordx4 v4, s[44:47], s60 offen lds
    s_add_u32 m0, s37, 3072
    s_add_u32 s60, s67, 24576
    buffer_load_dwordx4 v4, s[44:47], s60 offen lds
    s_waitcnt vmcnt(12)
    ds_read_b64_tr_b16 v[88:89], v9 offset:4096
    ds_read_b64_tr_b16 v[90:91], v9 offset:5120
    ds_read_b64_tr_b16 v[92:93], v10 offset:4096
    ds_read_b64_tr_b16 v[94:95], v10 offset:5120
    v_mfma_f32_32x32x16_bf16 v[24:39], v[96:99], v[112:115], v[24:39]
    v_mfma_f32_32x32x16_bf16 v[40:55], v[96:99], v[116:119], v[40:55]
    v_mfma_f32_32x32x16_bf16 v[72:87], v[100:103], v[116:119], v[72:87]
    v_mfma_f32_32x32x16_bf16 v[56:71], v[100:103], v[112:115], v[56:71]
    buffer_load_dwordx4 v[112:115], v2, s[48:51], s68 offen offset:1024 sc1
    buffer_load_dwordx4 v[116:119], v2, s[48:51], s69 offen offset:1024 sc1
    s_waitcnt lgkmcnt(0)
    s_add_u32 m0, s37, 4096
    s_add_u32 s60, s67, 32768
    buffer_load_dwordx4 v4, s[44:47], s60 offen lds
    s_add_u32 m0, s37, 5120
    s_add_u32 s60, s67, 40960
    buffer_load_dwordx4 v4, s[44:47], s60 offen lds
    s_waitcnt vmcnt(12)
    ds_read_b64_tr_b16 v[96:97], v9 offset:6144
    ds_read_b64_tr_b16 v[98:99], v9 offset:7168
    ds_read_b64_tr_b16 v[100:101], v10 offset:6144
    ds_read_b64_tr_b16 v[102:103], v10 offset:7168
    v_mfma_f32_32x32x16_bf16 v[24:39], v[88:91], v[120:123], v[24:39]
    v_mfma_f32_32x32x16_bf16 v[40:55], v[88:91], v[124:127], v[40:55]
    v_mfma_f32_32x32x16_bf16 v[72:87], v[92:95], v[124:127], v[72:87]
    v_mfma_f32_32x32x16_bf16 v[56:71], v[92:95], v[120:123], v[56:71]
    buffer_load_dwordx4 v[120:123], v2, s[48:51], s68 offen offset:2048 sc1
    buffer_load_dwordx4 v[124:127], v2, s[48:51], s69 offen offset:2048 sc1
    s_waitcnt lgkmcnt(0)
    s_add_u32 m0, s37, 6144
    s_add_u32 s60, s67, 49152
    buffer_load_dwordx4 v4, s[44:47], s60 offen lds
    s_add_u32 m0, s37, 7168
    s_add_u32 s60, s67, 57344
    buffer_load_dwordx4 v4, s[44:47], s60 offen lds
    s_waitcnt vmcnt(12)
    ds_read_b64_tr_b16 v[88:89], v9 offset:0
    ds_read_b64_tr_b16 v[90:91], v9 offset:1024
    ds_read_b64_tr_b16 v[92:93], v10 offset:0
    ds_read_b64_tr_b16 v[94:95], v10 offset:1024
    v_mfma_f32_32x32x16_bf16 v[24:39], v[96:99], v[128:131], v[24:39]
    v_mfma_f32_32x32x16_bf16 v[40:55], v[96:99], v[132:135], v[40:55]
    v_mfma_f32_32x32x16_bf16 v[72:87], v[100:103], v[132:135], v[72:87]
    v_mfma_f32_32x32x16_bf16 v[56:71], v[100:103], v[128:131], v[56:71]
    buffer_load_dwordx4 v[128:131], v2, s[48:51], s68 offen offset:3072 sc1
    buffer_load_dwordx4 v[132:135], v2, s[48:51], s69 offen offset:3072 sc1
    s_waitcnt lgkmcnt(0)
    s_lshl_b32 s67, s39, 16
    s_add_u32 s67, s67, s36
    s_lshl_b32 s60, s39, 12
    s_add_u32 s68, s60, s32
    s_add_u32 s69, s60, s33
    s_add_u32 s39, s39, 1
    s_cmp_eq_u32 s39, 7
    s_cselect_b32 s39, 0, s39
    s_add_u32 m0, s37, 0
    s_add_u32 s60, s67, 0
    buffer_load_dwordx4 v4, s[44:47], s60 offen lds
    s_add_u32 m0, s37, 1024
    s_add_u32 s60, s67, 8192
    buffer_load_dwordx4 v4, s[44:47], s60 offen lds
    s_waitcnt vmcnt(12)
    ds_read_b64_tr_b16 v[96:97], v9 offset:2048
    ds_read_b64_tr_b16 v[98:99], v9 offset:3072
    ds_read_b64_tr_b16 v[100:101], v10 offset:2048
    ds_read_b64_tr_b16 v[102:103], v10 offset:3072
    v_mfma_f32_32x32x16_bf16 v[24:39], v[88:91], v[104:107], v[24:39]
    v_mfma_f32_32x32x16_bf16 v[40:55], v[88:91], v[108:111], v[40:55]
    v_mfma_f32_32x32x16_bf16 v[72:87], v[92:95], v[108:111], v[72:87]
    v_mfma_f32_32x32x16_bf16 v[56:71], v[92:95], v[104:107], v[56:71]
    buffer_load_dwordx4 v[104:107], v2, s[48:51], s68 offen offset:0 sc1
    buffer_load_dwordx4 v[108:111], v2, s[48:51], s69 offen offset:0 sc1
    s_waitcnt lgkmcnt(0)
    s_add_u32 m0, s37, 2048
    s_add_u32 s60, s67, 16384
    buffer_load_dwordx4 v4, s[44:47], s60 offen lds
    s_add_u32 m0, s37, 3072
    s_add_u32 s60, s67, 24576
    buffer_load_dwordx4 v4, s[44:47], s60 offen lds
    s_waitcnt vmcnt(12)
    ds_read_b64_tr_b16 v[88:89], v9 offset:4096
    ds_read_b64_tr_b16 v[90:91], v9 offset:5120
    ds_read_b64_tr_b16 v[92:93], v10 offset:4096
    ds_read_b64_tr_b16 v[94:95], v10 offset:5120
    v_mfma_f32_32x32x16_bf16 v[24:39], v[96:99], v[112:115], v[24:39]
    v_mfma_f32_32x32x16_bf16 v[40:55], v[96:99], v[116:119], v[40:55]
    v_mfma_f32_32x32x16_bf16 v[72:87], v[100:103], v[116:119], v[72:87]
    v_mfma_f32_32x32x16_bf16 v[56:71], v[100:103], v[112:115], v[56:71]
    buffer_load_dwordx4 v[112:115], v2, s[48:51], s68 offen offset:1024 sc1
    buffer_load_dwordx4 v[116:119], v2, s[48:51], s69 offen offset:1024 sc1
    s_waitcnt lgkmcnt(0)
    s_add_u32 m0, s37, 4096
    s_add_u32 s60, s67, 32768
    buffer_load_dwordx4 v4, s[44:47], s60 offen lds
    s_add_u32 m0, s37, 5120
    s_add_u32 s60, s67, 40960
    buffer_load_dwordx4 v4, s[44:47], s60 offen lds
    s_waitcnt vmcnt(12)
    ds_read_b64_tr_b16 v[96:97], v9 offset:6144
    ds_read_b64_tr_b16 v[98:99], v9 offset:7168
    ds_read_b64_tr_b16 v[100:101], v10 offset:6144
    ds_read_b64_tr_b16 v[102:103], v10 offset:7168
    v_mfma_f32_32x32x16_bf16 v[24:39], v[88:91], v[120:123], v[24:39]
    v_mfma_f32_32x32x16_bf16 v[40:55], v[88:91], v[124:127], v[40:55]
    v_mfma_f32_32x32x16_bf16 v[72:87], v[92:95], v[124:127], v[72:87]
    v_mfma_f32_32x32x16_bf16 v[56:71], v[92:95], v[120:123], v[56:71]
    buffer_load_dwordx4 v[120:123], v2, s[48:51], s68 offen offset:2048 sc1
    buffer_load_dwordx4 v[124:127], v2, s[48:51], s69 offen offset:2048 sc1
    s_waitcnt lgkmcnt(0)
    s_add_u32 m0, s37, 6144
    s_add_u32 s60, s67, 49152
    buffer_load_dwordx4 v4, s[44:47], s60 offen lds
    s_add_u32 m0, s37, 7168
    s_add_u32 s60, s67, 57344
    buffer_load_dwordx4 v4, s[44:47], s60 offen lds
    s_waitcnt vmcnt(12)
    ds_read_b64_tr_b16 v[88:89], v9 offset:0
    ds_read_b64_tr_b16 v[90:91], v9 offset:1024
    ds_read_b64_tr_b16 v[92:93], v10 offset:0
    ds_read_b64_tr_b16 v[94:95], v10 offset:1024
    v_mfma_f32_32x32x16_bf16 v[24:39], v[96:99], v[128:131], v[24:39]
    v_mfma_f32_32x32x16_bf16 v[40:55], v[96:99], v[132:135], v[40:55]
    v_mfma_f32_32x32x16_bf16 v[72:87], v[100:103], v[132:135], v[72:87]
    v_mfma_f32_32x32x16_bf16 v[56:71], v[100:103], v[128:131], v[56:71]
    buffer_load_dwordx4 v[128:131], v2, s[48:51], s68 offen offset:3072 sc1
    buffer_load_dwordx4 v[132:135], v2, s[48:51], s69 offen offset:3072 sc1
    s_waitcnt lgkmcnt(0)
    s_add_u32 m0, s37, 0
    s_add_u32 s60, s38, 16384
    buffer_load_dwordx4 v4, s[40:43], s60 offen lds
    s_add_u32 m0, s37, 1024
    s_add_u32 s60, s38, 24576
    buffer_load_dwordx4 v4, s[40:43], s60 offen lds
    s_waitcnt vmcnt(12)
    ds_read_b64_tr_b16 v[96:97], v9 offset:2048
    ds_read_b64_tr_b16 v[98:99], v9 offset:3072
    ds_read_b64_tr_b16 v[100:101], v10 offset:2048
    ds_read_b64_tr_b16 v[102:103], v10 offset:3072
    v_mfma_f32_32x32x16_bf16 v[24:39], v[88:91], v[104:107], v[24:39]
    v_mfma_f32_32x32x16_bf16 v[40:55], v[88:91], v[108:111], v[40:55]
    v_mfma_f32_32x32x16_bf16 v[72:87], v[92:95], v[108:111], v[72:87]
    v_mfma_f32_32x32x16_bf16 v[56:71], v[92:95], v[104:107], v[56:71]
    s_waitcnt lgkmcnt(0)
    s_add_u32 m0, s37, 2048
    s_add_u32 s60, s38, 49152
    buffer_load_dwordx4 v4, s[40:43], s60 offen lds
    s_add_u32 m0, s37, 3072
    s_add_u32 s60, s38, 57344
    buffer_load_dwordx4 v4, s[40:43], s60 offen lds
    s_waitcnt vmcnt(10)
    ds_read_b64_tr_b16 v[88:89], v9 offset:4096
    ds_read_b64_tr_b16 v[90:91], v9 offset:5120
    ds_read_b64_tr_b16 v[92:93], v10 offset:4096
    ds_read_b64_tr_b16 v[94:95], v10 offset:5120
    v_mfma_f32_32x32x16_bf16 v[24:39], v[96:99], v[112:115], v[24:39]
    v_mfma_f32_32x32x16_bf16 v[40:55], v[96:99], v[116:119], v[40:55]
    v_mfma_f32_32x32x16_bf16 v[72:87], v[100:103], v[116:119], v[72:87]
    v_mfma_f32_32x32x16_bf16 v[56:71], v[100:103], v[112:115], v[56:71]
    s_waitcnt lgkmcnt(0)
    s_add_u32 m0, s37, 4096
    s_add_u32 s60, s38, 81920
    buffer_load_dwordx4 v4, s[40:43], s60 offen lds
    s_add_u32 m0, s37, 5120
    s_add_u32 s60, s38, 90112
    buffer_load_dwordx4 v4, s[40:43], s60 offen lds
    s_waitcnt vmcnt(8)
    ds_read_b64_tr_b16 v[96:97], v9 offset:6144
    ds_read_b64_tr_b16 v[98:99], v9 offset:7168
    ds_read_b64_tr_b16 v[100:101], v10 offset:6144
    ds_read_b64_tr_b16 v[102:103], v10 offset:7168
    v_mfma_f32_32x32x16_bf16 v[24:39], v[88:91], v[120:123], v[24:39]
    v_mfma_f32_32x32x16_bf16 v[40:55], v[88:91], v[124:127], v[40:55]
    v_mfma_f32_32x32x16_bf16 v[72:87], v[92:95], v[124:127], v[72:87]
    v_mfma_f32_32x32x16_bf16 v[56:71], v[92:95], v[120:123], v[56:71]
    s_waitcnt lgkmcnt(0)
    s_add_u32 m0, s37, 6144
    s_add_u32 s60, s38, 114688
    buffer_load_dwordx4 v4, s[40:43], s60 offen lds
    s_add_u32 m0, s37, 7168
    s_add_u32 s60, s38, 122880
    buffer_load_dwordx4 v4, s[40:43], s60 offen lds
    s_waitcnt vmcnt(8)
    v_mfma_f32_32x32x16_bf16 v[24:39], v[96:99], v[128:131], v[24:39]
    v_mfma_f32_32x32x16_bf16 v[40:55], v[96:99], v[132:135], v[40:55]
    v_mfma_f32_32x32x16_bf16 v[72:87], v[100:103], v[132:135], v[72:87]
    v_mfma_f32_32x32x16_bf16 v[56:71], v[100:103], v[128:131], v[56:71]
    s_setprio 3
    s_lshl_b32 s64, s76, 16
    s_lshl_b32 s60, s3, 13
    s_add_u32 s64, s64, s60
    s_add_u32 s64, s64, 2097152
    s_add_u32 s65, s64, 4096
    s_add_u32 s66, s64, 32768
    s_add_u32 s67, s64, 36864
    s_lshl_b32 s60, s3, 14
    v_add_u32 v6, s60, v2
    s_nop 7
    v_pk_mul_f32 v[24:25], v[24:25], v[14:15]
    v_pk_mul_f32 v[26:27], v[26:27], v[14:15]
    v_pk_mul_f32 v[28:29], v[28:29], v[14:15]
    v_pk_mul_f32 v[30:31], v[30:31], v[14:15]
    v_pk_mul_f32 v[32:33], v[32:33], v[14:15]
    v_pk_mul_f32 v[34:35], v[34:35], v[14:15]
    v_pk_mul_f32 v[36:37], v[36:37], v[14:15]
    v_pk_mul_f32 v[38:39], v[38:39], v[14:15]
    v_pk_mul_f32 v[40:41], v[40:41], v[16:17]
    v_pk_mul_f32 v[42:43], v[42:43], v[16:17]
    v_pk_mul_f32 v[44:45], v[44:45], v[16:17]
    v_pk_mul_f32 v[46:47], v[46:47], v[16:17]
    v_pk_mul_f32 v[48:49], v[48:49], v[16:17]
    v_pk_mul_f32 v[50:51], v[50:51], v[16:17]
    v_pk_mul_f32 v[52:53], v[52:53], v[16:17]
    v_pk_mul_f32 v[54:55], v[54:55], v[16:17]
    v_pk_mul_f32 v[56:57], v[56:57], v[14:15]
    v_pk_mul_f32 v[58:59], v[58:59], v[14:15]
    v_pk_mul_f32 v[60:61], v[60:61], v[14:15]
    v_pk_mul_f32 v[62:63], v[62:63], v[14:15]
    v_pk_mul_f32 v[64:65], v[64:65], v[14:15]
    v_pk_mul_f32 v[66:67], v[66:67], v[14:15]
    v_pk_mul_f32 v[68:69], v[68:69], v[14:15]
    v_pk_mul_f32 v[70:71], v[70:71], v[14:15]
    v_pk_mul_f32 v[72:73], v[72:73], v[16:17]
    v_pk_mul_f32 v[74:75], v[74:75], v[16:17]
    v_pk_mul_f32 v[76:77], v[76:77], v[16:17]
    v_pk_mul_f32 v[78:79], v[78:79], v[16:17]
    v_pk_mul_f32 v[80:81], v[80:81], v[16:17]
    v_pk_mul_f32 v[82:83], v[82:83], v[16:17]
    v_pk_mul_f32 v[84:85], v[84:85], v[16:17]
    v_pk_mul_f32 v[86:87], v[86:87], v[16:17]
SPIN_10:
    buffer_load_dwordx4 v[104:107], v2, s[48:51], s64 offen offset:0 sc1
    buffer_load_dwordx4 v[108:111], v2, s[48:51], s66 offen offset:0 sc1
    buffer_load_dwordx4 v[112:115], v2, s[48:51], s64 offen offset:2048 sc1
    buffer_load_dwordx4 v[116:119], v2, s[48:51], s66 offen offset:2048 sc1
    buffer_load_dwordx4 v[120:123], v2, s[48:51], s65 offen offset:0 sc1
    buffer_load_dwordx4 v[124:127], v2, s[48:51], s67 offen offset:0 sc1
    buffer_load_dwordx4 v[128:131], v2, s[48:51], s65 offen offset:2048 sc1
    buffer_load_dwordx4 v[132:135], v2, s[48:51], s67 offen offset:2048 sc1
SPINC_11:
    s_waitcnt vmcnt(0)
    v_max_u32 v11, v104, v105
    v_max3_u32 v11, v11, v106, v107
    v_max3_u32 v11, v11, v108, v109
    v_max3_u32 v11, v11, v110, v111
    v_max3_u32 v11, v11, v112, v113
    v_max3_u32 v11, v11, v114, v115
    v_max3_u32 v11, v11, v116, v117
    v_max3_u32 v11, v11, v118, v119
    v_max3_u32 v11, v11, v120, v121
    v_max3_u32 v11, v11, v122, v123
    v_max3_u32 v11, v11, v124, v125
    v_max3_u32 v11, v11, v126, v127
    v_max3_u32 v11, v11, v128, v129
    v_max3_u32 v11, v11, v130, v131
    v_max3_u32 v11, v11, v132, v133
    v_max3_u32 v11, v11, v134, v135
    v_cmp_eq_u32 vcc, -1, v11
    s_nop 4
    s_cbranch_vccz SPIND_12
    s_cmp_eq_u32 s100, 0
    s_cbranch_scc1 SPIND_12
    s_sub_u32 s100, s100, 1
    s_sleep 12
    s_branch SPIN_10
SPIND_12:
    s_setprio 0
    v_mfma_f32_32x32x16_bf16 v[24:39], v[136:139], v[104:107], v[24:39]
    v_mfma_f32_32x32x16_bf16 v[40:55], v[136:139], v[108:111], v[40:55]
    v_mfma_f32_32x32x16_bf16 v[56:71], v[140:143], v[104:107], v[56:71]
    v_mfma_f32_32x32x16_bf16 v[72:87], v[140:143], v[108:111], v[72:87]
    v_mfma_f32_32x32x16_bf16 v[24:39], v[144:147], v[112:115], v[24:39]
    v_mfma_f32_32x32x16_bf16 v[40:55], v[144:147], v[116:119], v[40:55]
    v_mfma_f32_32x32x16_bf16 v[56:71], v[148:151], v[112:115], v[56:71]
    v_mfma_f32_32x32x16_bf16 v[72:87], v[148:151], v[116:119], v[72:87]
    v_mfma_f32_32x32x16_bf16 v[24:39], v[152:155], v[120:123], v[24:39]
    v_mfma_f32_32x32x16_bf16 v[40:55], v[152:155], v[124:127], v[40:55]
    v_mfma_f32_32x32x16_bf16 v[56:71], v[156:159], v[120:123], v[56:71]
    v_mfma_f32_32x32x16_bf16 v[72:87], v[156:159], v[124:127], v[72:87]
    v_mfma_f32_32x32x16_bf16 v[24:39], v[160:163], v[128:131], v[24:39]
    v_mfma_f32_32x32x16_bf16 v[40:55], v[160:163], v[132:135], v[40:55]
    v_mfma_f32_32x32x16_bf16 v[56:71], v[164:167], v[128:131], v[56:71]
    v_mfma_f32_32x32x16_bf16 v[72:87], v[164:167], v[132:135], v[72:87]
    s_nop 15
    s_barrier
    ds_write_b128 v6, v[24:27] offset:0
    ds_write_b128 v6, v[28:31] offset:1024
    ds_write_b128 v6, v[32:35] offset:2048
    ds_write_b128 v6, v[36:39] offset:3072
    ds_write_b128 v6, v[40:43] offset:4096
    ds_write_b128 v6, v[44:47] offset:5120
    ds_write_b128 v6, v[48:51] offset:6144
    ds_write_b128 v6, v[52:55] offset:7168
    ds_write_b128 v6, v[56:59] offset:8192
    ds_write_b128 v6, v[60:63] offset:9216
    ds_write_b128 v6, v[64:67] offset:10240
    ds_write_b128 v6, v[68:71] offset:11264
    ds_write_b128 v6, v[72:75] offset:12288
    ds_write_b128 v6, v[76:79] offset:13312
    ds_write_b128 v6, v[80:83] offset:14336
    ds_write_b128 v6, v[84:87] offset:15360
    s_waitcnt lgkmcnt(0)
    s_barrier
    s_endpgm
COMPUTE:
    s_lshr_b32 s60, s30, 2
    s_lshl_b32 s96, s31, 2
    s_and_b32 s61, s30, 3
    s_add_u32 s96, s96, s61
    s_lshl_b32 s96, s96, 4
    s_add_u32 s96, s96, s56
    s_lshl_b32 s96, s96, 1
    s_add_u32 s96, s96, s60
    s_lshl_b32 s96, s96, 10
    s_mov_b32 s40, 0xffff
    s_mov_b32 s41, 0xffff
    s_cmp_ge_u32 s56, 14
    s_cbranch_scc1 SP_COMPUTE
    v_and_b32 v14, 15, v1
    v_bfe_u32 v16, v1, 1, 3
    v_xor_b32 v16, v16, v6
    s_and_b32 s60, s30, 3
    s_lshl_b32 s60, s60, 12
    v_lshlrev_b32 v17, 7, v14
    v_add_u32 v17, s60, v17
    v_xor_b32 v18, 0, v16
    v_lshl_add_u32 v160, v18, 4, v17
    v_xor_b32 v162, 0x1000, v160
    v_add_u32 v164, 147456, v160
    v_add_u32 v166, 147456, v162
    v_xor_b32 v18, 4, v16
    v_lshl_add_u32 v161, v18, 4, v17
    v_xor_b32 v163, 0x1000, v161
    v_add_u32 v165, 147456, v161
    v_add_u32 v167, 147456, v163
    s_lshr_b32 s60, s30, 2
    s_lshl_b32 s92, s60, 1
    s_and_b32 s61, s30, 1
    s_add_u32 s92, s92, s61
    v_bfe_u32 v16, v1, 2, 2
    v_lshl_add_u32 v17, v6, 3, v16
    v_and_b32 v19, 3, v1
    v_and_b32 v18, 1, v6
    v_xor_b32 v14, s60, v18
    v_lshlrev_b32 v9, 6, v17
    v_lshl_add_u32 v9, v14, 5, v9
    v_and_b32 v14, 1, v1
    v_lshl_add_u32 v9, v14, 4, v9
    v_bfe_u32 v14, v1, 1, 1
    v_lshl_add_u32 v9, v14, 3, v9
    v_lshl_add_u32 v18, v18, 2, v16
    s_lshl_b32 s61, s92, 1
    v_xor_b32 v18, s61, v18
    v_lshlrev_b32 v4, 8, v17
    v_lshl_add_u32 v4, v18, 5, v4
    v_lshl_add_u32 v4, v19, 3, v4
    s_and_b32 s60, s30, 2
    s_lshl_b32 s60, s60, 1
    s_add_u32 s60, s60, s92
    s_lshl_b32 s60, s60, 1
    s_and_b32 s61, s30, 1
    s_add_u32 s60, s60, s61
    s_lshl_b32 s60, s60, 11
    s_add_u32 s60, s60, 131072
    v_and_b32 v14, 15, v1
    v_lshlrev_b32 v14, 4, v14
    v_and_b32 v15, 1, v6
    v_lshl_add_u32 v14, v15, 9, v14
    v_lshrrev_b32 v15, 1, v6
    v_lshl_add_u32 v14, v15, 3, v14
    v_add_u32 v14, s60, v14
    v_xor_b32 v15, 0x800, v14
    v_xor_b32 v5, 32, v4
    v_add_u32 v4, 49152, v4
    v_add_u32 v5, 49152, v5
    v_add_u32 v6, 0x10000, v4
    v_add_u32 v7, 0x10000, v5
    s_waitcnt lgkmcnt(0)
    s_mov_b32 s48, s28
    s_mov_b32 s49, s29
    s_mov_b32 s50, 16777216
    s_mov_b32 s51, 0x00020000
    s_mov_b32 s52, s24
    s_mov_b32 s53, s25
    s_mov_b32 s54, 2097152
    s_mov_b32 s55, 0x00020000
    s_mov_b32 s64, 0xbfb8aa3b
    s_mov_b32 s65, 0xbfb8aa3b
    s_mov_b32 s66, 1.0
    s_mov_b32 s67, 1.0
    s_waitcnt vmcnt(0)
    s_barrier
    ds_read_b64_tr_b16 v[32:33], v9 offset:36864
    ds_read_b64_tr_b16 v[34:35], v9 offset:37120
    ds_read_b128 v[16:19], v160 offset:16384
    ds_read_b128 v[20:23], v160 offset:18432
    ds_read_b128 v[24:27], v162 offset:16384
    ds_read_b128 v[28:31], v162 offset:18432
    ds_read_b64_tr_b16 v[36:37], v4 offset:32768
    ds_read_b64_tr_b16 v[38:39], v4 offset:33792
    ds_read_b64_tr_b16 v[40:41], v5 offset:32768
    ds_read_b64_tr_b16 v[42:43], v5 offset:33792
    ds_read_b64_tr_b16 v[44:45], v4 offset:49152
    ds_read_b64_tr_b16 v[46:47], v4 offset:50176
    ds_read_b64_tr_b16 v[48:49], v5 offset:49152
    ds_read_b64_tr_b16 v[50:51], v5 offset:50176
    s_waitcnt lgkmcnt(0)
    v_mfma_f32_16x16x32_bf16 v[152:155], v[32:35], v[16:19], 0
    ds_read_b64_tr_b16 v[68:69], v9 offset:38912
    v_mfma_f32_16x16x32_bf16 v[156:159], v[32:35], v[20:23], 0
    ds_read_b64_tr_b16 v[70:71], v9 offset:39168
    v_mfma_f32_16x16x32_bf16 v[92:95], v[36:39], v[20:23], 0
    ds_read_b128 v[52:55], v161 offset:16384
    v_mfma_f32_16x16x32_bf16 v[88:91], v[36:39], v[16:19], 0
    ds_read_b128 v[56:59], v161 offset:18432
    v_mfma_f32_16x16x32_bf16 v[96:99], v[36:39], v[24:27], 0
    ds_read_b128 v[60:63], v163 offset:16384
    v_mfma_f32_16x16x32_bf16 v[100:103], v[36:39], v[28:31], 0
    ds_read_b128 v[64:67], v163 offset:18432
    v_mfma_f32_16x16x32_bf16 v[116:119], v[40:43], v[28:31], 0
    ds_read_b64_tr_b16 v[72:73], v4 offset:40960
    v_mfma_f32_16x16x32_bf16 v[112:115], v[40:43], v[24:27], 0
    ds_read_b64_tr_b16 v[74:75], v4 offset:41984
    v_mfma_f32_16x16x32_bf16 v[108:111], v[40:43], v[20:23], 0
    ds_read_b64_tr_b16 v[76:77], v5 offset:40960
    v_mfma_f32_16x16x32_bf16 v[104:107], v[40:43], v[16:19], 0
    ds_read_b64_tr_b16 v[78:79], v5 offset:41984
    v_mfma_f32_16x16x32_bf16 v[120:123], v[44:47], v[16:19], 0
    ds_read_b64_tr_b16 v[80:81], v4 offset:57344
    v_mfma_f32_16x16x32_bf16 v[124:127], v[44:47], v[20:23], 0
    ds_read_b64_tr_b16 v[82:83], v4 offset:58368
    v_mfma_f32_16x16x32_bf16 v[128:131], v[44:47], v[24:27], 0
    ds_read_b64_tr_b16 v[84:85], v5 offset:57344
    v_mfma_f32_16x16x32_bf16 v[132:135], v[44:47], v[28:31], 0
    ds_read_b64_tr_b16 v[86:87], v5 offset:58368
    v_mfma_f32_16x16x32_bf16 v[148:151], v[48:51], v[28:31], 0
    v_mfma_f32_16x16x32_bf16 v[144:147], v[48:51], v[24:27], 0
    v_mfma_f32_16x16x32_bf16 v[140:143], v[48:51], v[20:23], 0
    v_mfma_f32_16x16x32_bf16 v[136:139], v[48:51], v[16:19], 0
    s_waitcnt lgkmcnt(0)
    s_barrier
    v_mfma_f32_16x16x32_bf16 v[152:155], v[68:71], v[52:55], v[152:155]
    ds_read_b64_tr_b16 v[32:33], v9 offset:40960
    v_mfma_f32_16x16x32_bf16 v[156:159], v[68:71], v[56:59], v[156:159]
    ds_read_b64_tr_b16 v[34:35], v9 offset:41216
    v_mfma_f32_16x16x32_bf16 v[92:95], v[72:75], v[56:59], v[92:95]
    ds_read_b128 v[16:19], v164 offset:0
    v_mfma_f32_16x16x32_bf16 v[88:91], v[72:75], v[52:55], v[88:91]
    ds_read_b128 v[20:23], v164 offset:2048
    v_mfma_f32_16x16x32_bf16 v[96:99], v[72:75], v[60:63], v[96:99]
    ds_read_b128 v[24:27], v166 offset:0
    v_mfma_f32_16x16x32_bf16 v[100:103], v[72:75], v[64:67], v[100:103]
    ds_read_b128 v[28:31], v166 offset:2048
    v_mfma_f32_16x16x32_bf16 v[116:119], v[76:79], v[64:67], v[116:119]
    ds_read_b64_tr_b16 v[36:37], v6 offset:0
    v_mfma_f32_16x16x32_bf16 v[112:115], v[76:79], v[60:63], v[112:115]
    ds_read_b64_tr_b16 v[38:39], v6 offset:1024
    v_mfma_f32_16x16x32_bf16 v[108:111], v[76:79], v[56:59], v[108:111]
    ds_read_b64_tr_b16 v[40:41], v7 offset:0
    v_mfma_f32_16x16x32_bf16 v[104:107], v[76:79], v[52:55], v[104:107]
    ds_read_b64_tr_b16 v[42:43], v7 offset:1024
    v_mfma_f32_16x16x32_bf16 v[120:123], v[80:83], v[52:55], v[120:123]
    ds_read_b64_tr_b16 v[44:45], v6 offset:16384
    v_mfma_f32_16x16x32_bf16 v[124:127], v[80:83], v[56:59], v[124:127]
    ds_read_b64_tr_b16 v[46:47], v6 offset:17408
    v_mfma_f32_16x16x32_bf16 v[128:131], v[80:83], v[60:63], v[128:131]
    ds_read_b64_tr_b16 v[48:49], v7 offset:16384
    v_mfma_f32_16x16x32_bf16 v[132:135], v[80:83], v[64:67], v[132:135]
    ds_read_b64_tr_b16 v[50:51], v7 offset:17408
    v_mfma_f32_16x16x32_bf16 v[148:151], v[84:87], v[64:67], v[148:151]
    v_mfma_f32_16x16x32_bf16 v[144:147], v[84:87], v[60:63], v[144:147]
    v_mfma_f32_16x16x32_bf16 v[140:143], v[84:87], v[56:59], v[140:143]
    v_mfma_f32_16x16x32_bf16 v[136:139], v[84:87], v[52:55], v[136:139]
    s_waitcnt lgkmcnt(0)
    v_mfma_f32_16x16x32_bf16 v[152:155], v[32:35], v[16:19], v[152:155]
    ds_read_b64_tr_b16 v[68:69], v9 offset:43008
    v_mfma_f32_16x16x32_bf16 v[156:159], v[32:35], v[20:23], v[156:159]
    ds_read_b64_tr_b16 v[70:71], v9 offset:43264
    v_mfma_f32_16x16x32_bf16 v[92:95], v[36:39], v[20:23], v[92:95]
    ds_read_b128 v[52:55], v165 offset:0
    v_mfma_f32_16x16x32_bf16 v[88:91], v[36:39], v[16:19], v[88:91]
    ds_read_b128 v[56:59], v165 offset:2048
    v_mfma_f32_16x16x32_bf16 v[96:99], v[36:39], v[24:27], v[96:99]
    ds_read_b128 v[60:63], v167 offset:0
    v_mfma_f32_16x16x32_bf16 v[100:103], v[36:39], v[28:31], v[100:103]
    ds_read_b128 v[64:67], v167 offset:2048
    v_mfma_f32_16x16x32_bf16 v[116:119], v[40:43], v[28:31], v[116:119]
    ds_read_b64_tr_b16 v[72:73], v6 offset:8192
    v_mfma_f32_16x16x32_bf16 v[112:115], v[40:43], v[24:27], v[112:115]
    ds_read_b64_tr_b16 v[74:75], v6 offset:9216
    v_mfma_f32_16x16x32_bf16 v[108:111], v[40:43], v[20:23], v[108:111]
    ds_read_b64_tr_b16 v[76:77], v7 offset:8192
    v_mfma_f32_16x16x32_bf16 v[104:107], v[40:43], v[16:19], v[104:107]
    ds_read_b64_tr_b16 v[78:79], v7 offset:9216
    v_mfma_f32_16x16x32_bf16 v[120:123], v[44:47], v[16:19], v[120:123]
    ds_read_b64_tr_b16 v[80:81], v6 offset:24576
    v_mfma_f32_16x16x32_bf16 v[124:127], v[44:47], v[20:23], v[124:127]
    ds_read_b64_tr_b16 v[82:83], v6 offset:25600
    v_mfma_f32_16x16x32_bf16 v[128:131], v[44:47], v[24:27], v[128:131]
    ds_read_b64_tr_b16 v[84:85], v7 offset:24576
    v_mfma_f32_16x16x32_bf16 v[132:135], v[44:47], v[28:31], v[132:135]
    ds_read_b64_tr_b16 v[86:87], v7 offset:25600
    v_mfma_f32_16x16x32_bf16 v[148:151], v[48:51], v[28:31], v[148:151]
    v_mfma_f32_16x16x32_bf16 v[144:147], v[48:51], v[24:27], v[144:147]
    v_mfma_f32_16x16x32_bf16 v[140:143], v[48:51], v[20:23], v[140:143]
    v_mfma_f32_16x16x32_bf16 v[136:139], v[48:51], v[16:19], v[136:139]
    s_waitcnt lgkmcnt(0)
    s_barrier
    v_mfma_f32_16x16x32_bf16 v[152:155], v[68:71], v[52:55], v[152:155]
    ds_read_b64_tr_b16 v[32:33], v9 offset:32768
    v_mfma_f32_16x16x32_bf16 v[156:159], v[68:71], v[56:59], v[156:159]
    ds_read_b64_tr_b16 v[34:35], v9 offset:33024
    v_mfma_f32_16x16x32_bf16 v[92:95], v[72:75], v[56:59], v[92:95]
    ds_read_b128 v[16:19], v160 offset:0
    v_mfma_f32_16x16x32_bf16 v[88:91], v[72:75], v[52:55], v[88:91]
    ds_read_b128 v[20:23], v160 offset:2048
    v_mfma_f32_16x16x32_bf16 v[96:99], v[72:75], v[60:63], v[96:99]
    ds_read_b128 v[24:27], v162 offset:0
    v_mfma_f32_16x16x32_bf16 v[100:103], v[72:75], v[64:67], v[100:103]
    ds_read_b128 v[28:31], v162 offset:2048
    v_mfma_f32_16x16x32_bf16 v[116:119], v[76:79], v[64:67], v[116:119]
    ds_read_b64_tr_b16 v[36:37], v4 offset:0
    v_mfma_f32_16x16x32_bf16 v[112:115], v[76:79], v[60:63], v[112:115]
    ds_read_b64_tr_b16 v[38:39], v4 offset:1024
    v_mfma_f32_16x16x32_bf16 v[108:111], v[76:79], v[56:59], v[108:111]
    ds_read_b64_tr_b16 v[40:41], v5 offset:0
    v_mfma_f32_16x16x32_bf16 v[104:107], v[76:79], v[52:55], v[104:107]
    ds_read_b64_tr_b16 v[42:43], v5 offset:1024
    v_mfma_f32_16x16x32_bf16 v[120:123], v[80:83], v[52:55], v[120:123]
    ds_read_b64_tr_b16 v[44:45], v4 offset:16384
    v_mfma_f32_16x16x32_bf16 v[124:127], v[80:83], v[56:59], v[124:127]
    ds_read_b64_tr_b16 v[46:47], v4 offset:17408
    v_mfma_f32_16x16x32_bf16 v[128:131], v[80:83], v[60:63], v[128:131]
    ds_read_b64_tr_b16 v[48:49], v5 offset:16384
    v_mfma_f32_16x16x32_bf16 v[132:135], v[80:83], v[64:67], v[132:135]
    ds_read_b64_tr_b16 v[50:51], v5 offset:17408
    v_mfma_f32_16x16x32_bf16 v[148:151], v[84:87], v[64:67], v[148:151]
    v_mfma_f32_16x16x32_bf16 v[144:147], v[84:87], v[60:63], v[144:147]
    v_mfma_f32_16x16x32_bf16 v[140:143], v[84:87], v[56:59], v[140:143]
    v_mfma_f32_16x16x32_bf16 v[136:139], v[84:87], v[52:55], v[136:139]
    s_waitcnt lgkmcnt(0)
    v_mfma_f32_16x16x32_bf16 v[152:155], v[32:35], v[16:19], v[152:155]
    ds_read_b64_tr_b16 v[68:69], v9 offset:34816
    v_mfma_f32_16x16x32_bf16 v[156:159], v[32:35], v[20:23], v[156:159]
    ds_read_b64_tr_b16 v[70:71], v9 offset:35072
    v_mfma_f32_16x16x32_bf16 v[92:95], v[36:39], v[20:23], v[92:95]
    ds_read_b128 v[52:55], v161 offset:0
    v_mfma_f32_16x16x32_bf16 v[88:91], v[36:39], v[16:19], v[88:91]
    ds_read_b128 v[56:59], v161 offset:2048
    v_mfma_f32_16x16x32_bf16 v[96:99], v[36:39], v[24:27], v[96:99]
    ds_read_b128 v[60:63], v163 offset:0
    v_mfma_f32_16x16x32_bf16 v[100:103], v[36:39], v[28:31], v[100:103]
    ds_read_b128 v[64:67], v163 offset:2048
    v_mfma_f32_16x16x32_bf16 v[116:119], v[40:43], v[28:31], v[116:119]
    ds_read_b64_tr_b16 v[72:73], v4 offset:8192
    v_mfma_f32_16x16x32_bf16 v[112:115], v[40:43], v[24:27], v[112:115]
    ds_read_b64_tr_b16 v[74:75], v4 offset:9216
    v_mfma_f32_16x16x32_bf16 v[108:111], v[40:43], v[20:23], v[108:111]
    ds_read_b64_tr_b16 v[76:77], v5 offset:8192
    v_mfma_f32_16x16x32_bf16 v[104:107], v[40:43], v[16:19], v[104:107]
    ds_read_b64_tr_b16 v[78:79], v5 offset:9216
    v_mfma_f32_16x16x32_bf16 v[120:123], v[44:47], v[16:19], v[120:123]
    ds_read_b64_tr_b16 v[80:81], v4 offset:24576
    v_mfma_f32_16x16x32_bf16 v[124:127], v[44:47], v[20:23], v[124:127]
    ds_read_b64_tr_b16 v[82:83], v4 offset:25600
    v_mfma_f32_16x16x32_bf16 v[128:131], v[44:47], v[24:27], v[128:131]
    ds_read_b64_tr_b16 v[84:85], v5 offset:24576
    v_mfma_f32_16x16x32_bf16 v[132:135], v[44:47], v[28:31], v[132:135]
    ds_read_b64_tr_b16 v[86:87], v5 offset:25600
    v_mfma_f32_16x16x32_bf16 v[148:151], v[48:51], v[28:31], v[148:151]
    v_mfma_f32_16x16x32_bf16 v[144:147], v[48:51], v[24:27], v[144:147]
    v_mfma_f32_16x16x32_bf16 v[140:143], v[48:51], v[20:23], v[140:143]
    v_mfma_f32_16x16x32_bf16 v[136:139], v[48:51], v[16:19], v[136:139]
    s_waitcnt lgkmcnt(0)
    s_barrier
    v_mfma_f32_16x16x32_bf16 v[152:155], v[68:71], v[52:55], v[152:155]
    ds_read_b64_tr_b16 v[32:33], v9 offset:36864
    v_mfma_f32_16x16x32_bf16 v[156:159], v[68:71], v[56:59], v[156:159]
    ds_read_b64_tr_b16 v[34:35], v9 offset:37120
    v_mfma_f32_16x16x32_bf16 v[92:95], v[72:75], v[56:59], v[92:95]
    ds_read_b128 v[16:19], v160 offset:16384
    v_mfma_f32_16x16x32_bf16 v[88:91], v[72:75], v[52:55], v[88:91]
    ds_read_b128 v[20:23], v160 offset:18432
    v_mfma_f32_16x16x32_bf16 v[96:99], v[72:75], v[60:63], v[96:99]
    ds_read_b128 v[24:27], v162 offset:16384
    v_mfma_f32_16x16x32_bf16 v[100:103], v[72:75], v[64:67], v[100:103]
    ds_read_b128 v[28:31], v162 offset:18432
    v_mfma_f32_16x16x32_bf16 v[116:119], v[76:79], v[64:67], v[116:119]
    ds_read_b64_tr_b16 v[36:37], v4 offset:32768
    v_mfma_f32_16x16x32_bf16 v[112:115], v[76:79], v[60:63], v[112:115]
    ds_read_b64_tr_b16 v[38:39], v4 offset:33792
    v_mfma_f32_16x16x32_bf16 v[108:111], v[76:79], v[56:59], v[108:111]
    ds_read_b64_tr_b16 v[40:41], v5 offset:32768
    v_mfma_f32_16x16x32_bf16 v[104:107], v[76:79], v[52:55], v[104:107]
    ds_read_b64_tr_b16 v[42:43], v5 offset:33792
    v_mfma_f32_16x16x32_bf16 v[120:123], v[80:83], v[52:55], v[120:123]
    ds_read_b64_tr_b16 v[44:45], v4 offset:49152
    v_mfma_f32_16x16x32_bf16 v[124:127], v[80:83], v[56:59], v[124:127]
    ds_read_b64_tr_b16 v[46:47], v4 offset:50176
    v_mfma_f32_16x16x32_bf16 v[128:131], v[80:83], v[60:63], v[128:131]
    ds_read_b64_tr_b16 v[48:49], v5 offset:49152
    v_mfma_f32_16x16x32_bf16 v[132:135], v[80:83], v[64:67], v[132:135]
    ds_read_b64_tr_b16 v[50:51], v5 offset:50176
    v_mfma_f32_16x16x32_bf16 v[148:151], v[84:87], v[64:67], v[148:151]
    v_mfma_f32_16x16x32_bf16 v[144:147], v[84:87], v[60:63], v[144:147]
    v_mfma_f32_16x16x32_bf16 v[140:143], v[84:87], v[56:59], v[140:143]
    v_mfma_f32_16x16x32_bf16 v[136:139], v[84:87], v[52:55], v[136:139]
    s_waitcnt lgkmcnt(0)
    v_mfma_f32_16x16x32_bf16 v[152:155], v[32:35], v[16:19], v[152:155]
    ds_read_b64_tr_b16 v[68:69], v9 offset:38912
    v_mfma_f32_16x16x32_bf16 v[156:159], v[32:35], v[20:23], v[156:159]
    ds_read_b64_tr_b16 v[70:71], v9 offset:39168
    v_mfma_f32_16x16x32_bf16 v[92:95], v[36:39], v[20:23], v[92:95]
    ds_read_b128 v[52:55], v161 offset:16384
    v_mfma_f32_16x16x32_bf16 v[88:91], v[36:39], v[16:19], v[88:91]
    ds_read_b128 v[56:59], v161 offset:18432
    v_mfma_f32_16x16x32_bf16 v[96:99], v[36:39], v[24:27], v[96:99]
    ds_read_b128 v[60:63], v163 offset:16384
    v_mfma_f32_16x16x32_bf16 v[100:103], v[36:39], v[28:31], v[100:103]
    ds_read_b128 v[64:67], v163 offset:18432
    v_mfma_f32_16x16x32_bf16 v[116:119], v[40:43], v[28:31], v[116:119]
    ds_read_b64_tr_b16 v[72:73], v4 offset:40960
    v_mfma_f32_16x16x32_bf16 v[112:115], v[40:43], v[24:27], v[112:115]
    ds_read_b64_tr_b16 v[74:75], v4 offset:41984
    v_mfma_f32_16x16x32_bf16 v[108:111], v[40:43], v[20:23], v[108:111]
    ds_read_b64_tr_b16 v[76:77], v5 offset:40960
    v_mfma_f32_16x16x32_bf16 v[104:107], v[40:43], v[16:19], v[104:107]
    ds_read_b64_tr_b16 v[78:79], v5 offset:41984
    v_mfma_f32_16x16x32_bf16 v[120:123], v[44:47], v[16:19], v[120:123]
    ds_read_b64_tr_b16 v[80:81], v4 offset:57344
    v_mfma_f32_16x16x32_bf16 v[124:127], v[44:47], v[20:23], v[124:127]
    ds_read_b64_tr_b16 v[82:83], v4 offset:58368
    v_mfma_f32_16x16x32_bf16 v[128:131], v[44:47], v[24:27], v[128:131]
    ds_read_b64_tr_b16 v[84:85], v5 offset:57344
    v_mfma_f32_16x16x32_bf16 v[132:135], v[44:47], v[28:31], v[132:135]
    ds_read_b64_tr_b16 v[86:87], v5 offset:58368
    v_mfma_f32_16x16x32_bf16 v[148:151], v[48:51], v[28:31], v[148:151]
    v_mfma_f32_16x16x32_bf16 v[144:147], v[48:51], v[24:27], v[144:147]
    v_mfma_f32_16x16x32_bf16 v[140:143], v[48:51], v[20:23], v[140:143]
    v_mfma_f32_16x16x32_bf16 v[136:139], v[48:51], v[16:19], v[136:139]
    s_waitcnt lgkmcnt(0)
    s_barrier
    v_mfma_f32_16x16x32_bf16 v[152:155], v[68:71], v[52:55], v[152:155]
    ds_read_b64_tr_b16 v[32:33], v9 offset:40960
    v_mfma_f32_16x16x32_bf16 v[156:159], v[68:71], v[56:59], v[156:159]
    ds_read_b64_tr_b16 v[34:35], v9 offset:41216
    v_mfma_f32_16x16x32_bf16 v[92:95], v[72:75], v[56:59], v[92:95]
    ds_read_b128 v[16:19], v164 offset:0
    v_mfma_f32_16x16x32_bf16 v[88:91], v[72:75], v[52:55], v[88:91]
    ds_read_b128 v[20:23], v164 offset:2048
    v_mfma_f32_16x16x32_bf16 v[96:99], v[72:75], v[60:63], v[96:99]
    ds_read_b128 v[24:27], v166 offset:0
    v_mfma_f32_16x16x32_bf16 v[100:103], v[72:75], v[64:67], v[100:103]
    ds_read_b128 v[28:31], v166 offset:2048
    v_mfma_f32_16x16x32_bf16 v[116:119], v[76:79], v[64:67], v[116:119]
    ds_read_b64_tr_b16 v[36:37], v6 offset:0
    v_mfma_f32_16x16x32_bf16 v[112:115], v[76:79], v[60:63], v[112:115]
    ds_read_b64_tr_b16 v[38:39], v6 offset:1024
    v_mfma_f32_16x16x32_bf16 v[108:111], v[76:79], v[56:59], v[108:111]
    ds_read_b64_tr_b16 v[40:41], v7 offset:0
    v_mfma_f32_16x16x32_bf16 v[104:107], v[76:79], v[52:55], v[104:107]
    ds_read_b64_tr_b16 v[42:43], v7 offset:1024
    v_mfma_f32_16x16x32_bf16 v[120:123], v[80:83], v[52:55], v[120:123]
    ds_read_b64_tr_b16 v[44:45], v6 offset:16384
    v_mfma_f32_16x16x32_bf16 v[124:127], v[80:83], v[56:59], v[124:127]
    ds_read_b64_tr_b16 v[46:47], v6 offset:17408
    v_mfma_f32_16x16x32_bf16 v[128:131], v[80:83], v[60:63], v[128:131]
    ds_read_b64_tr_b16 v[48:49], v7 offset:16384
    v_mfma_f32_16x16x32_bf16 v[132:135], v[80:83], v[64:67], v[132:135]
    ds_read_b64_tr_b16 v[50:51], v7 offset:17408
    v_mfma_f32_16x16x32_bf16 v[148:151], v[84:87], v[64:67], v[148:151]
    v_mfma_f32_16x16x32_bf16 v[144:147], v[84:87], v[60:63], v[144:147]
    v_mfma_f32_16x16x32_bf16 v[140:143], v[84:87], v[56:59], v[140:143]
    v_mfma_f32_16x16x32_bf16 v[136:139], v[84:87], v[52:55], v[136:139]
    s_waitcnt lgkmcnt(0)
    v_mfma_f32_16x16x32_bf16 v[152:155], v[32:35], v[16:19], v[152:155]
    ds_read_b64_tr_b16 v[68:69], v9 offset:43008
    v_mfma_f32_16x16x32_bf16 v[156:159], v[32:35], v[20:23], v[156:159]
    ds_read_b64_tr_b16 v[70:71], v9 offset:43264
    v_mfma_f32_16x16x32_bf16 v[92:95], v[36:39], v[20:23], v[92:95]
    ds_read_b128 v[52:55], v165 offset:0
    v_mfma_f32_16x16x32_bf16 v[88:91], v[36:39], v[16:19], v[88:91]
    ds_read_b128 v[56:59], v165 offset:2048
    v_mfma_f32_16x16x32_bf16 v[96:99], v[36:39], v[24:27], v[96:99]
    ds_read_b128 v[60:63], v167 offset:0
    v_mfma_f32_16x16x32_bf16 v[100:103], v[36:39], v[28:31], v[100:103]
    ds_read_b128 v[64:67], v167 offset:2048
    v_mfma_f32_16x16x32_bf16 v[116:119], v[40:43], v[28:31], v[116:119]
    ds_read_b64_tr_b16 v[72:73], v6 offset:8192
    v_mfma_f32_16x16x32_bf16 v[112:115], v[40:43], v[24:27], v[112:115]
    ds_read_b64_tr_b16 v[74:75], v6 offset:9216
    v_mfma_f32_16x16x32_bf16 v[108:111], v[40:43], v[20:23], v[108:111]
    ds_read_b64_tr_b16 v[76:77], v7 offset:8192
    v_mfma_f32_16x16x32_bf16 v[104:107], v[40:43], v[16:19], v[104:107]
    ds_read_b64_tr_b16 v[78:79], v7 offset:9216
    v_mfma_f32_16x16x32_bf16 v[120:123], v[44:47], v[16:19], v[120:123]
    ds_read_b64_tr_b16 v[80:81], v6 offset:24576
    v_mfma_f32_16x16x32_bf16 v[124:127], v[44:47], v[20:23], v[124:127]
    ds_read_b64_tr_b16 v[82:83], v6 offset:25600
    v_mfma_f32_16x16x32_bf16 v[128:131], v[44:47], v[24:27], v[128:131]
    ds_read_b64_tr_b16 v[84:85], v7 offset:24576
    v_mfma_f32_16x16x32_bf16 v[132:135], v[44:47], v[28:31], v[132:135]
    ds_read_b64_tr_b16 v[86:87], v7 offset:25600
    v_mfma_f32_16x16x32_bf16 v[148:151], v[48:51], v[28:31], v[148:151]
    v_mfma_f32_16x16x32_bf16 v[144:147], v[48:51], v[24:27], v[144:147]
    v_mfma_f32_16x16x32_bf16 v[140:143], v[48:51], v[20:23], v[140:143]
    v_mfma_f32_16x16x32_bf16 v[136:139], v[48:51], v[16:19], v[136:139]
    s_waitcnt lgkmcnt(0)
    s_barrier
    v_mfma_f32_16x16x32_bf16 v[152:155], v[68:71], v[52:55], v[152:155]
    ds_read_b64_tr_b16 v[32:33], v9 offset:32768
    v_mfma_f32_16x16x32_bf16 v[156:159], v[68:71], v[56:59], v[156:159]
    ds_read_b64_tr_b16 v[34:35], v9 offset:33024
    v_mfma_f32_16x16x32_bf16 v[92:95], v[72:75], v[56:59], v[92:95]
    ds_read_b128 v[16:19], v160 offset:0
    v_mfma_f32_16x16x32_bf16 v[88:91], v[72:75], v[52:55], v[88:91]
    ds_read_b128 v[20:23], v160 offset:2048
    v_mfma_f32_16x16x32_bf16 v[96:99], v[72:75], v[60:63], v[96:99]
    ds_read_b128 v[24:27], v162 offset:0
    v_mfma_f32_16x16x32_bf16 v[100:103], v[72:75], v[64:67], v[100:103]
    ds_read_b128 v[28:31], v162 offset:2048
    v_mfma_f32_16x16x32_bf16 v[116:119], v[76:79], v[64:67], v[116:119]
    ds_read_b64_tr_b16 v[36:37], v4 offset:0
    v_mfma_f32_16x16x32_bf16 v[112:115], v[76:79], v[60:63], v[112:115]
    ds_read_b64_tr_b16 v[38:39], v4 offset:1024
    v_mfma_f32_16x16x32_bf16 v[108:111], v[76:79], v[56:59], v[108:111]
    ds_read_b64_tr_b16 v[40:41], v5 offset:0
    v_mfma_f32_16x16x32_bf16 v[104:107], v[76:79], v[52:55], v[104:107]
    ds_read_b64_tr_b16 v[42:43], v5 offset:1024
    v_mfma_f32_16x16x32_bf16 v[120:123], v[80:83], v[52:55], v[120:123]
    ds_read_b64_tr_b16 v[44:45], v4 offset:16384
    v_mfma_f32_16x16x32_bf16 v[124:127], v[80:83], v[56:59], v[124:127]
    ds_read_b64_tr_b16 v[46:47], v4 offset:17408
    v_mfma_f32_16x16x32_bf16 v[128:131], v[80:83], v[60:63], v[128:131]
    ds_read_b64_tr_b16 v[48:49], v5 offset:16384
    v_mfma_f32_16x16x32_bf16 v[132:135], v[80:83], v[64:67], v[132:135]
    ds_read_b64_tr_b16 v[50:51], v5 offset:17408
    v_mfma_f32_16x16x32_bf16 v[148:151], v[84:87], v[64:67], v[148:151]
    v_mfma_f32_16x16x32_bf16 v[144:147], v[84:87], v[60:63], v[144:147]
    v_mfma_f32_16x16x32_bf16 v[140:143], v[84:87], v[56:59], v[140:143]
    v_mfma_f32_16x16x32_bf16 v[136:139], v[84:87], v[52:55], v[136:139]
    s_waitcnt lgkmcnt(0)
    v_mfma_f32_16x16x32_bf16 v[152:155], v[32:35], v[16:19], v[152:155]
    ds_read_b64_tr_b16 v[68:69], v9 offset:34816
    v_mfma_f32_16x16x32_bf16 v[156:159], v[32:35], v[20:23], v[156:159]
    ds_read_b64_tr_b16 v[70:71], v9 offset:35072
    v_mfma_f32_16x16x32_bf16 v[92:95], v[36:39], v[20:23], v[92:95]
    ds_read_b128 v[52:55], v161 offset:0
    v_mfma_f32_16x16x32_bf16 v[88:91], v[36:39], v[16:19], v[88:91]
    ds_read_b128 v[56:59], v161 offset:2048
    v_mfma_f32_16x16x32_bf16 v[96:99], v[36:39], v[24:27], v[96:99]
    ds_read_b128 v[60:63], v163 offset:0
    v_mfma_f32_16x16x32_bf16 v[100:103], v[36:39], v[28:31], v[100:103]
    ds_read_b128 v[64:67], v163 offset:2048
    v_mfma_f32_16x16x32_bf16 v[116:119], v[40:43], v[28:31], v[116:119]
    ds_read_b64_tr_b16 v[72:73], v4 offset:8192
    v_mfma_f32_16x16x32_bf16 v[112:115], v[40:43], v[24:27], v[112:115]
    ds_read_b64_tr_b16 v[74:75], v4 offset:9216
    v_mfma_f32_16x16x32_bf16 v[108:111], v[40:43], v[20:23], v[108:111]
    ds_read_b64_tr_b16 v[76:77], v5 offset:8192
    v_mfma_f32_16x16x32_bf16 v[104:107], v[40:43], v[16:19], v[104:107]
    ds_read_b64_tr_b16 v[78:79], v5 offset:9216
    v_mfma_f32_16x16x32_bf16 v[120:123], v[44:47], v[16:19], v[120:123]
    ds_read_b64_tr_b16 v[80:81], v4 offset:24576
    v_mfma_f32_16x16x32_bf16 v[124:127], v[44:47], v[20:23], v[124:127]
    ds_read_b64_tr_b16 v[82:83], v4 offset:25600
    v_mfma_f32_16x16x32_bf16 v[128:131], v[44:47], v[24:27], v[128:131]
    ds_read_b64_tr_b16 v[84:85], v5 offset:24576
    v_mfma_f32_16x16x32_bf16 v[132:135], v[44:47], v[28:31], v[132:135]
    ds_read_b64_tr_b16 v[86:87], v5 offset:25600
    v_mfma_f32_16x16x32_bf16 v[148:151], v[48:51], v[28:31], v[148:151]
    v_mfma_f32_16x16x32_bf16 v[144:147], v[48:51], v[24:27], v[144:147]
    v_mfma_f32_16x16x32_bf16 v[140:143], v[48:51], v[20:23], v[140:143]
    v_mfma_f32_16x16x32_bf16 v[136:139], v[48:51], v[16:19], v[136:139]
    s_waitcnt lgkmcnt(0)
    s_barrier
    v_mfma_f32_16x16x32_bf16 v[152:155], v[68:71], v[52:55], v[152:155]
    ds_read_b64_tr_b16 v[32:33], v9 offset:36864
    v_mfma_f32_16x16x32_bf16 v[156:159], v[68:71], v[56:59], v[156:159]
    ds_read_b64_tr_b16 v[34:35], v9 offset:37120
    v_mfma_f32_16x16x32_bf16 v[92:95], v[72:75], v[56:59], v[92:95]
    ds_read_b128 v[16:19], v160 offset:16384
    v_mfma_f32_16x16x32_bf16 v[88:91], v[72:75], v[52:55], v[88:91]
    ds_read_b128 v[20:23], v160 offset:18432
    v_mfma_f32_16x16x32_bf16 v[96:99], v[72:75], v[60:63], v[96:99]
    ds_read_b128 v[24:27], v162 offset:16384
    v_mfma_f32_16x16x32_bf16 v[100:103], v[72:75], v[64:67], v[100:103]
    ds_read_b128 v[28:31], v162 offset:18432
    v_mfma_f32_16x16x32_bf16 v[116:119], v[76:79], v[64:67], v[116:119]
    ds_read_b64_tr_b16 v[36:37], v4 offset:32768
    v_mfma_f32_16x16x32_bf16 v[112:115], v[76:79], v[60:63], v[112:115]
    ds_read_b64_tr_b16 v[38:39], v4 offset:33792
    v_mfma_f32_16x16x32_bf16 v[108:111], v[76:79], v[56:59], v[108:111]
    ds_read_b64_tr_b16 v[40:41], v5 offset:32768
    v_mfma_f32_16x16x32_bf16 v[104:107], v[76:79], v[52:55], v[104:107]
    ds_read_b64_tr_b16 v[42:43], v5 offset:33792
    v_mfma_f32_16x16x32_bf16 v[120:123], v[80:83], v[52:55], v[120:123]
    ds_read_b64_tr_b16 v[44:45], v4 offset:49152
    v_mfma_f32_16x16x32_bf16 v[124:127], v[80:83], v[56:59], v[124:127]
    ds_read_b64_tr_b16 v[46:47], v4 offset:50176
    v_mfma_f32_16x16x32_bf16 v[128:131], v[80:83], v[60:63], v[128:131]
    ds_read_b64_tr_b16 v[48:49], v5 offset:49152
    v_mfma_f32_16x16x32_bf16 v[132:135], v[80:83], v[64:67], v[132:135]
    ds_read_b64_tr_b16 v[50:51], v5 offset:50176
    v_mfma_f32_16x16x32_bf16 v[148:151], v[84:87], v[64:67], v[148:151]
    v_mfma_f32_16x16x32_bf16 v[144:147], v[84:87], v[60:63], v[144:147]
    v_mfma_f32_16x16x32_bf16 v[140:143], v[84:87], v[56:59], v[140:143]
    v_mfma_f32_16x16x32_bf16 v[136:139], v[84:87], v[52:55], v[136:139]
    s_waitcnt lgkmcnt(0)
    v_mfma_f32_16x16x32_bf16 v[152:155], v[32:35], v[16:19], v[152:155]
    ds_read_b64_tr_b16 v[68:69], v9 offset:38912
    v_mfma_f32_16x16x32_bf16 v[156:159], v[32:35], v[20:23], v[156:159]
    ds_read_b64_tr_b16 v[70:71], v9 offset:39168
    v_mfma_f32_16x16x32_bf16 v[92:95], v[36:39], v[20:23], v[92:95]
    ds_read_b128 v[52:55], v161 offset:16384
    v_mfma_f32_16x16x32_bf16 v[88:91], v[36:39], v[16:19], v[88:91]
    ds_read_b128 v[56:59], v161 offset:18432
    v_mfma_f32_16x16x32_bf16 v[96:99], v[36:39], v[24:27], v[96:99]
    ds_read_b128 v[60:63], v163 offset:16384
    v_mfma_f32_16x16x32_bf16 v[100:103], v[36:39], v[28:31], v[100:103]
    ds_read_b128 v[64:67], v163 offset:18432
    v_mfma_f32_16x16x32_bf16 v[116:119], v[40:43], v[28:31], v[116:119]
    ds_read_b64_tr_b16 v[72:73], v4 offset:40960
    v_mfma_f32_16x16x32_bf16 v[112:115], v[40:43], v[24:27], v[112:115]
    ds_read_b64_tr_b16 v[74:75], v4 offset:41984
    v_mfma_f32_16x16x32_bf16 v[108:111], v[40:43], v[20:23], v[108:111]
    ds_read_b64_tr_b16 v[76:77], v5 offset:40960
    v_mfma_f32_16x16x32_bf16 v[104:107], v[40:43], v[16:19], v[104:107]
    ds_read_b64_tr_b16 v[78:79], v5 offset:41984
    v_mfma_f32_16x16x32_bf16 v[120:123], v[44:47], v[16:19], v[120:123]
    ds_read_b64_tr_b16 v[80:81], v4 offset:57344
    v_mfma_f32_16x16x32_bf16 v[124:127], v[44:47], v[20:23], v[124:127]
    ds_read_b64_tr_b16 v[82:83], v4 offset:58368
    v_mfma_f32_16x16x32_bf16 v[128:131], v[44:47], v[24:27], v[128:131]
    ds_read_b64_tr_b16 v[84:85], v5 offset:57344
    v_mfma_f32_16x16x32_bf16 v[132:135], v[44:47], v[28:31], v[132:135]
    ds_read_b64_tr_b16 v[86:87], v5 offset:58368
    v_mfma_f32_16x16x32_bf16 v[148:151], v[48:51], v[28:31], v[148:151]
    v_mfma_f32_16x16x32_bf16 v[144:147], v[48:51], v[24:27], v[144:147]
    v_mfma_f32_16x16x32_bf16 v[140:143], v[48:51], v[20:23], v[140:143]
    v_mfma_f32_16x16x32_bf16 v[136:139], v[48:51], v[16:19], v[136:139]
    s_waitcnt lgkmcnt(0)
    s_barrier
    v_mfma_f32_16x16x32_bf16 v[152:155], v[68:71], v[52:55], v[152:155]
    ds_read_b64_tr_b16 v[32:33], v9 offset:40960
    v_mfma_f32_16x16x32_bf16 v[156:159], v[68:71], v[56:59], v[156:159]
    ds_read_b64_tr_b16 v[34:35], v9 offset:41216
    v_mfma_f32_16x16x32_bf16 v[92:95], v[72:75], v[56:59], v[92:95]
    ds_read_b128 v[16:19], v164 offset:0
    v_mfma_f32_16x16x32_bf16 v[88:91], v[72:75], v[52:55], v[88:91]
    ds_read_b128 v[20:23], v164 offset:2048
    v_mfma_f32_16x16x32_bf16 v[96:99], v[72:75], v[60:63], v[96:99]
    ds_read_b128 v[24:27], v166 offset:0
    v_mfma_f32_16x16x32_bf16 v[100:103], v[72:75], v[64:67], v[100:103]
    ds_read_b128 v[28:31], v166 offset:2048
    v_mfma_f32_16x16x32_bf16 v[116:119], v[76:79], v[64:67], v[116:119]
    ds_read_b64_tr_b16 v[36:37], v6 offset:0
    v_mfma_f32_16x16x32_bf16 v[112:115], v[76:79], v[60:63], v[112:115]
    ds_read_b64_tr_b16 v[38:39], v6 offset:1024
    v_mfma_f32_16x16x32_bf16 v[108:111], v[76:79], v[56:59], v[108:111]
    ds_read_b64_tr_b16 v[40:41], v7 offset:0
    v_mfma_f32_16x16x32_bf16 v[104:107], v[76:79], v[52:55], v[104:107]
    ds_read_b64_tr_b16 v[42:43], v7 offset:1024
    v_mfma_f32_16x16x32_bf16 v[120:123], v[80:83], v[52:55], v[120:123]
    ds_read_b64_tr_b16 v[44:45], v6 offset:16384
    v_mfma_f32_16x16x32_bf16 v[124:127], v[80:83], v[56:59], v[124:127]
    ds_read_b64_tr_b16 v[46:47], v6 offset:17408
    v_mfma_f32_16x16x32_bf16 v[128:131], v[80:83], v[60:63], v[128:131]
    ds_read_b64_tr_b16 v[48:49], v7 offset:16384
    v_mfma_f32_16x16x32_bf16 v[132:135], v[80:83], v[64:67], v[132:135]
    ds_read_b64_tr_b16 v[50:51], v7 offset:17408
    v_mfma_f32_16x16x32_bf16 v[148:151], v[84:87], v[64:67], v[148:151]
    v_mfma_f32_16x16x32_bf16 v[144:147], v[84:87], v[60:63], v[144:147]
    v_mfma_f32_16x16x32_bf16 v[140:143], v[84:87], v[56:59], v[140:143]
    v_mfma_f32_16x16x32_bf16 v[136:139], v[84:87], v[52:55], v[136:139]
    s_waitcnt lgkmcnt(0)
    v_mfma_f32_16x16x32_bf16 v[152:155], v[32:35], v[16:19], v[152:155]
    ds_read_b64_tr_b16 v[68:69], v9 offset:43008
    v_mfma_f32_16x16x32_bf16 v[156:159], v[32:35], v[20:23], v[156:159]
    ds_read_b64_tr_b16 v[70:71], v9 offset:43264
    v_mfma_f32_16x16x32_bf16 v[92:95], v[36:39], v[20:23], v[92:95]
    ds_read_b128 v[52:55], v165 offset:0
    v_mfma_f32_16x16x32_bf16 v[88:91], v[36:39], v[16:19], v[88:91]
    ds_read_b128 v[56:59], v165 offset:2048
    v_mfma_f32_16x16x32_bf16 v[96:99], v[36:39], v[24:27], v[96:99]
    ds_read_b128 v[60:63], v167 offset:0
    v_mfma_f32_16x16x32_bf16 v[100:103], v[36:39], v[28:31], v[100:103]
    ds_read_b128 v[64:67], v167 offset:2048
    v_mfma_f32_16x16x32_bf16 v[116:119], v[40:43], v[28:31], v[116:119]
    ds_read_b64_tr_b16 v[72:73], v6 offset:8192
    v_mfma_f32_16x16x32_bf16 v[112:115], v[40:43], v[24:27], v[112:115]
    ds_read_b64_tr_b16 v[74:75], v6 offset:9216
    v_mfma_f32_16x16x32_bf16 v[108:111], v[40:43], v[20:23], v[108:111]
    ds_read_b64_tr_b16 v[76:77], v7 offset:8192
    v_mfma_f32_16x16x32_bf16 v[104:107], v[40:43], v[16:19], v[104:107]
    ds_read_b64_tr_b16 v[78:79], v7 offset:9216
    v_mfma_f32_16x16x32_bf16 v[120:123], v[44:47], v[16:19], v[120:123]
    ds_read_b64_tr_b16 v[80:81], v6 offset:24576
    v_mfma_f32_16x16x32_bf16 v[124:127], v[44:47], v[20:23], v[124:127]
    ds_read_b64_tr_b16 v[82:83], v6 offset:25600
    v_mfma_f32_16x16x32_bf16 v[128:131], v[44:47], v[24:27], v[128:131]
    ds_read_b64_tr_b16 v[84:85], v7 offset:24576
    v_mfma_f32_16x16x32_bf16 v[132:135], v[44:47], v[28:31], v[132:135]
    ds_read_b64_tr_b16 v[86:87], v7 offset:25600
    v_mfma_f32_16x16x32_bf16 v[148:151], v[48:51], v[28:31], v[148:151]
    s_mov_b32 s60, 4325376
    v_mfma_f32_16x16x32_bf16 v[144:147], v[48:51], v[24:27], v[144:147]
    buffer_load_dword v10, v3, s[48:51], s60 offen sc1
    v_mfma_f32_16x16x32_bf16 v[140:143], v[48:51], v[20:23], v[140:143]
    v_mfma_f32_16x16x32_bf16 v[136:139], v[48:51], v[16:19], v[136:139]
    s_waitcnt lgkmcnt(0)
    s_barrier
    v_mfma_f32_16x16x32_bf16 v[152:155], v[68:71], v[52:55], v[152:155]
    v_and_b32 v12, 27, v1
    v_cmp_eq_u32 vcc, 16, v12
    v_mfma_f32_16x16x32_bf16 v[156:159], v[68:71], v[56:59], v[156:159]
    v_mov_b32 v12, 0x3f803f80
    v_mov_b32 v8, 0xdddd
    v_mfma_f32_16x16x32_bf16 v[92:95], v[72:75], v[56:59], v[92:95]
    v_cndmask_b32 v32, 0, v12, vcc
    v_mov_b32 v33, v32
    v_mfma_f32_16x16x32_bf16 v[88:91], v[72:75], v[52:55], v[88:91]
    v_mov_b64 v[34:35], v[32:33]
    v_mov_b64 v[36:37], v[32:33]
    v_mfma_f32_16x16x32_bf16 v[96:99], v[72:75], v[60:63], v[96:99]
    v_mov_b64 v[38:39], v[32:33]
    v_mov_b64 v[40:41], v[32:33]
    v_mfma_f32_16x16x32_bf16 v[100:103], v[72:75], v[64:67], v[100:103]
    v_mov_b64 v[42:43], v[32:33]
    v_mov_b64 v[44:45], v[32:33]
    v_mfma_f32_16x16x32_bf16 v[116:119], v[76:79], v[64:67], v[116:119]
    v_mov_b64 v[46:47], v[32:33]
    v_mov_b64 v[16:17], 0
    v_mfma_f32_16x16x32_bf16 v[112:115], v[76:79], v[60:63], v[112:115]
    v_mov_b64 v[18:19], 0
    v_mov_b64 v[20:21], 0
    v_mfma_f32_16x16x32_bf16 v[108:111], v[76:79], v[56:59], v[108:111]
    v_mov_b64 v[22:23], 0
    v_mov_b64 v[24:25], 0
    v_mfma_f32_16x16x32_bf16 v[104:107], v[76:79], v[52:55], v[104:107]
    v_mov_b64 v[26:27], 0
    v_mov_b64 v[28:29], 0
    v_mfma_f32_16x16x32_bf16 v[120:123], v[80:83], v[52:55], v[120:123]
    v_mov_b64 v[30:31], 0
    v_mov_b32 v13, v2
    v_mfma_f32_16x16x32_bf16 v[124:127], v[80:83], v[56:59], v[124:127]
    v_mov_b32 v11, 0
    v_mfma_f32_16x16x32_bf16 v[128:131], v[80:83], v[60:63], v[128:131]
    v_mfma_f32_16x16x32_bf16 v[132:135], v[80:83], v[64:67], v[132:135]
    v_mfma_f32_16x16x32_bf16 v[148:151], v[84:87], v[64:67], v[148:151]
    v_mfma_f32_16x16x32_bf16 v[144:147], v[84:87], v[60:63], v[144:147]
    v_mfma_f32_16x16x32_bf16 v[140:143], v[84:87], v[56:59], v[140:143]
    v_mfma_f32_16x16x32_bf16 v[136:139], v[84:87], v[52:55], v[136:139]
    v_cvt_pk_bf16_f32 v48, v152, v153
    v_cvt_pk_bf16_f32 v49, v154, v155
    v_cvt_pk_bf16_f32 v50, v156, v157
    v_cvt_pk_bf16_f32 v51, v158, v159
    s_nop 1
    v_permlane16_swap_b32 v48, v50
    v_permlane16_swap_b32 v49, v51
    v_pk_mul_f32 v[88:89], v[88:89], s[64:65]
    v_pk_mul_f32 v[90:91], v[90:91], s[64:65]
    v_pk_mul_f32 v[92:93], v[92:93], s[64:65]
    v_pk_mul_f32 v[94:95], v[94:95], s[64:65]
    v_pk_mul_f32 v[96:97], v[96:97], s[64:65]
    v_pk_mul_f32 v[98:99], v[98:99], s[64:65]
    v_pk_mul_f32 v[100:101], v[100:101], s[64:65]
    v_pk_mul_f32 v[102:103], v[102:103], s[64:65]
    v_exp_f32 v88, v88
    v_exp_f32 v89, v89
    v_exp_f32 v90, v90
    v_exp_f32 v91, v91
    v_exp_f32 v92, v92
    v_exp_f32 v93, v93
    v_exp_f32 v94, v94
    v_exp_f32 v95, v95
    v_exp_f32 v96, v96
    v_exp_f32 v97, v97
    v_exp_f32 v98, v98
    v_exp_f32 v99, v99
    v_exp_f32 v100, v100
    v_exp_f32 v101, v101
    v_exp_f32 v102, v102
    v_exp_f32 v103, v103
    v_pk_add_f32 v[88:89], v[88:89], s[66:67]
    v_pk_add_f32 v[90:91], v[90:91], s[66:67]
    v_pk_add_f32 v[92:93], v[92:93], s[66:67]
    v_pk_add_f32 v[94:95], v[94:95], s[66:67]
    v_pk_add_f32 v[96:97], v[96:97], s[66:67]
    v_pk_add_f32 v[98:99], v[98:99], s[66:67]
    v_pk_add_f32 v[100:101], v[100:101], s[66:67]
    v_pk_add_f32 v[102:103], v[102:103], s[66:67]
    v_rcp_f32 v88, v88
    v_rcp_f32 v89, v89
    v_rcp_f32 v90, v90
    v_rcp_f32 v91, v91
    v_rcp_f32 v92, v92
    v_rcp_f32 v93, v93
    v_rcp_f32 v94, v94
    v_rcp_f32 v95, v95
    v_rcp_f32 v96, v96
    v_rcp_f32 v97, v97
    v_rcp_f32 v98, v98
    v_rcp_f32 v99, v99
    v_rcp_f32 v100, v100
    v_rcp_f32 v101, v101
    v_rcp_f32 v102, v102
    v_rcp_f32 v103, v103
    v_pk_mul_f32 v[88:89], v[88:89], v[120:121]
    v_pk_mul_f32 v[90:91], v[90:91], v[122:123]
    v_pk_mul_f32 v[92:93], v[92:93], v[124:125]
    v_pk_mul_f32 v[94:95], v[94:95], v[126:127]
    v_pk_mul_f32 v[96:97], v[96:97], v[128:129]
    v_pk_mul_f32 v[98:99], v[98:99], v[130:131]
    v_pk_mul_f32 v[100:101], v[100:101], v[132:133]
    v_pk_mul_f32 v[102:103], v[102:103], v[134:135]
    v_cvt_pk_bf16_f32 v120, v88, v89
    v_cvt_pk_bf16_f32 v121, v90, v91
    v_cvt_pk_bf16_f32 v122, v92, v93
    v_cvt_pk_bf16_f32 v123, v94, v95
    v_cvt_pk_bf16_f32 v124, v96, v97
    v_cvt_pk_bf16_f32 v125, v98, v99
    v_cvt_pk_bf16_f32 v126, v100, v101
    v_cvt_pk_bf16_f32 v127, v102, v103
    ds_write_b64 v14, v[120:121] offset:0
    ds_write_b64 v14, v[122:123] offset:256
    ds_write_b64 v15, v[124:125] offset:0
    ds_write_b64 v15, v[126:127] offset:256
    v_pk_mul_f32 v[104:105], v[104:105], s[64:65]
    v_pk_mul_f32 v[106:107], v[106:107], s[64:65]
    v_pk_mul_f32 v[108:109], v[108:109], s[64:65]
    v_pk_mul_f32 v[110:111], v[110:111], s[64:65]
    v_pk_mul_f32 v[112:113], v[112:113], s[64:65]
    v_pk_mul_f32 v[114:115], v[114:115], s[64:65]
    v_pk_mul_f32 v[116:117], v[116:117], s[64:65]
    v_pk_mul_f32 v[118:119], v[118:119], s[64:65]
    s_waitcnt vmcnt(0)
    v_exp_f32 v104, v104
    v_exp_f32 v105, v105
    v_max_f32_dpp v10, v10, v10 quad_perm:[1,0,3,2] row_mask:0xf bank_mask:0xf
    v_exp_f32 v106, v106
    v_exp_f32 v107, v107
    v_max_f32_dpp v10, v10, v10 quad_perm:[2,3,0,1] row_mask:0xf bank_mask:0xf
    v_exp_f32 v108, v108
    v_exp_f32 v109, v109
    v_max_f32_dpp v10, v10, v10 row_half_mirror row_mask:0xf bank_mask:0xf
    v_exp_f32 v110, v110
    v_exp_f32 v111, v111
    v_max_f32_dpp v10, v10, v10 row_mirror row_mask:0xf bank_mask:0xf
    v_mov_b32 v12, v10
    v_exp_f32 v112, v112
    v_exp_f32 v113, v113
    v_permlane16_swap_b32 v10, v12
    v_exp_f32 v114, v114
    v_exp_f32 v115, v115
    v_max_f32 v10, v10, v12
    v_mov_b32 v12, v10
    v_exp_f32 v116, v116
    v_exp_f32 v117, v117
    v_permlane32_swap_b32 v10, v12
    v_exp_f32 v118, v118
    v_exp_f32 v119, v119
    v_max_f32 v10, v10, v12
    v_pk_add_f32 v[104:105], v[104:105], s[66:67]
    v_pk_add_f32 v[106:107], v[106:107], s[66:67]
    v_pk_add_f32 v[108:109], v[108:109], s[66:67]
    v_pk_add_f32 v[110:111], v[110:111], s[66:67]
    v_pk_add_f32 v[112:113], v[112:113], s[66:67]
    v_pk_add_f32 v[114:115], v[114:115], s[66:67]
    v_pk_add_f32 v[116:117], v[116:117], s[66:67]
    v_pk_add_f32 v[118:119], v[118:119], s[66:67]
    v_rcp_f32 v104, v104
    v_rcp_f32 v105, v105
    v_rcp_f32 v106, v106
    v_rcp_f32 v107, v107
    v_rcp_f32 v108, v108
    v_rcp_f32 v109, v109
    v_rcp_f32 v110, v110
    v_rcp_f32 v111, v111
    v_rcp_f32 v112, v112
    v_rcp_f32 v113, v113
    v_rcp_f32 v114, v114
    v_rcp_f32 v115, v115
    v_rcp_f32 v116, v116
    v_rcp_f32 v117, v117
    v_rcp_f32 v118, v118
    v_rcp_f32 v119, v119
    v_pk_mul_f32 v[104:105], v[104:105], v[136:137]
    v_pk_mul_f32 v[106:107], v[106:107], v[138:139]
    v_pk_mul_f32 v[108:109], v[108:109], v[140:141]
    v_pk_mul_f32 v[110:111], v[110:111], v[142:143]
    v_pk_mul_f32 v[112:113], v[112:113], v[144:145]
    v_pk_mul_f32 v[114:115], v[114:115], v[146:147]
    v_pk_mul_f32 v[116:117], v[116:117], v[148:149]
    v_pk_mul_f32 v[118:119], v[118:119], v[150:151]
    v_cvt_pk_bf16_f32 v136, v104, v105
    v_cvt_pk_bf16_f32 v137, v106, v107
    v_cvt_pk_bf16_f32 v138, v108, v109
    v_cvt_pk_bf16_f32 v139, v110, v111
    v_cvt_pk_bf16_f32 v140, v112, v113
    v_cvt_pk_bf16_f32 v141, v114, v115
    v_cvt_pk_bf16_f32 v142, v116, v117
    v_cvt_pk_bf16_f32 v143, v118, v119
    ds_write_b64 v14, v[136:137] offset:1024
    ds_write_b64 v14, v[138:139] offset:1280
    ds_write_b64 v15, v[140:141] offset:1024
    ds_write_b64 v15, v[142:143] offset:1280
QJOIN:
    v_dot2c_f32_bf16 v11, v48, v48
    v_dot2c_f32_bf16 v11, v49, v49
    v_dot2c_f32_bf16 v11, v50, v50
    v_dot2c_f32_bf16 v11, v51, v51
    v_mul_f32 v10, 0x3f851eb8, v10
    s_nop 1
    v_mov_b32 v12, v11
    s_nop 1
    v_permlane32_swap_b32 v11, v12
    s_nop 1
    v_add_f32 v11, v11, v12
    v_mul_f32 v11, v11, v10
    v_sqrt_f32 v11, v11
    s_mov_b32 s60, 0x42400000
    v_cmp_nle_f32 vcc, v11, s60
    v_sub_f32 v52, 0, v11
    v_sub_f32 v53, 0, v11
    v_mov_b64 v[54:55], v[52:53]
    v_mov_b64 v[56:57], v[52:53]
    v_mov_b64 v[58:59], v[52:53]
    v_mov_b64 v[60:61], v[52:53]
    v_mov_b64 v[62:63], v[52:53]
    v_mov_b64 v[64:65], v[52:53]
    v_mov_b64 v[66:67], v[52:53]
    s_waitcnt lgkmcnt(0)
    s_barrier
    s_cbranch_vccz ATT_GO
    v_mov_b32 v11, 0xff800000
    v_mov_b32 v12, v2
    s_mov_b32 s60, 64
MAXLOOP:
    ds_read_b128 v[68:71], v12
    v_add_u32 v12, 0x800, v12
    s_waitcnt lgkmcnt(0)
    v_mfma_f32_32x32x16_bf16 v[88:103], v[68:71], v[48:51], 0
    s_nop 15
    v_max3_f32 v11, v11, v88, v89
    v_max3_f32 v11, v11, v90, v91
    v_max3_f32 v11, v11, v92, v93
    v_max3_f32 v11, v11, v94, v95
    v_max3_f32 v11, v11, v96, v97
    v_max3_f32 v11, v11, v98, v99
    v_max3_f32 v11, v11, v100, v101
    v_max3_f32 v11, v11, v102, v103
    s_sub_u32 s60, s60, 1
    s_cmp_lg_u32 s60, 0
    s_cbranch_scc1 MAXLOOP
    v_mov_b32 v12, v11
    s_nop 1
    v_permlane32_swap_b32 v11, v12
    s_nop 1
    v_max_f32 v11, v11, v12
    v_sub_f32 v52, 0, v11
    v_sub_f32 v53, 0, v11
    v_sub_f32 v54, 0, v11
    v_sub_f32 v55, 0, v11
    v_sub_f32 v56, 0, v11
    v_sub_f32 v57, 0, v11
    v_sub_f32 v58, 0, v11
    v_sub_f32 v59, 0, v11
    v_sub_f32 v60, 0, v11
    v_sub_f32 v61, 0, v11
    v_sub_f32 v62, 0, v11
    v_sub_f32 v63, 0, v11
    v_sub_f32 v64, 0, v11
    v_sub_f32 v65, 0, v11
    v_sub_f32 v66, 0, v11
    v_sub_f32 v67, 0, v11
ATT_GO:
    ds_read_b128 v[68:71], v13 offset:0
    ds_read_b128 v[72:75], v13 offset:2048
    s_mov_b64 exec, s[40:41]
    ds_read_b128 v[32:35], v13 offset:1024
    ds_read_b128 v[36:39], v13 offset:1280
    s_mov_b64 exec, -1
    ds_read_b128 v[76:79], v13 offset:4096
    ds_read_b128 v[80:83], v13 offset:6144
    v_and_b32 v10, 31, v1
    v_lshlrev_b32 v12, 2, v10
    s_lshr_b32 s60, s96, 15
    s_lshl_b32 s60, s60, 7
    s_add_u32 s60, s60, 4329472
    buffer_load_dword v163, v12, s[48:51], s60 offen sc1
    s_waitcnt lgkmcnt(4)
    v_mfma_f32_32x32x16_bf16 v[88:103], v[68:71], v[48:51], v[52:67]
    s_mov_b32 s60, 8
    s_setprio 1
    s_mov_b32 s61, 99
    s_cmp_ge_u32 s30, 4
    s_cbranch_scc1 PRIO_SET
    s_setprio 2
    s_mov_b32 s61, 1
PRIO_SET:
    s_nop 11
    v_exp_f32 v88, v88
    v_exp_f32 v89, v89
    s_branch ATT_ENTRY
.p2align 6
ATT_LOOP:
    s_cmp_lg_u32 s60, s61
    s_cbranch_scc1 PRIO_KEEP
    s_setprio 0
PRIO_KEEP:
    v_exp_f32 v88, v88
    v_exp_f32 v89, v89
    v_smfmac_f32_32x32x32_bf16 v[16:31], v[44:47], v[112:119], v8
    ds_read_b128 v[80:83], v13 offset:6144
ATT_ENTRY:
    v_exp_f32 v90, v90
    v_exp_f32 v91, v91
    v_exp_f32 v92, v92
    v_exp_f32 v93, v93
    v_mfma_f32_32x32x16_bf16 v[104:119], v[72:75], v[48:51], v[52:67]
    s_waitcnt lgkmcnt(1)
    v_exp_f32 v94, v94
    v_exp_f32 v95, v95
    v_exp_f32 v96, v96
    v_exp_f32 v97, v97
    v_exp_f32 v98, v98
    v_smfmac_f32_32x32x32_bf16 v[16:31], v[32:35], v[88:95], v8
    s_mov_b64 exec, s[40:41]
    ds_read_b128 v[40:43], v13 offset:3072
    ds_read_b128 v[44:47], v13 offset:3328
    s_mov_b64 exec, -1
    v_exp_f32 v99, v99
    v_exp_f32 v100, v100
    v_exp_f32 v101, v101
    v_exp_f32 v102, v102
    v_exp_f32 v103, v103
    v_exp_f32 v104, v104
    v_exp_f32 v105, v105
    v_smfmac_f32_32x32x32_bf16 v[16:31], v[36:39], v[96:103], v8
    ds_read_b128 v[68:71], v13 offset:8192
    v_exp_f32 v106, v106
    v_exp_f32 v107, v107
    v_exp_f32 v108, v108
    v_exp_f32 v109, v109
    v_mfma_f32_32x32x16_bf16 v[88:103], v[76:79], v[48:51], v[52:67]
    s_waitcnt lgkmcnt(1)
    v_exp_f32 v110, v110
    v_exp_f32 v111, v111
    v_exp_f32 v112, v112
    v_exp_f32 v113, v113
    v_exp_f32 v114, v114
    v_smfmac_f32_32x32x32_bf16 v[16:31], v[40:43], v[104:111], v8
    s_mov_b64 exec, s[40:41]
    ds_read_b128 v[32:35], v13 offset:5120
    ds_read_b128 v[36:39], v13 offset:5376
    s_mov_b64 exec, -1
    v_exp_f32 v115, v115
    v_exp_f32 v116, v116
    v_exp_f32 v117, v117
    v_exp_f32 v118, v118
    v_exp_f32 v119, v119
    v_exp_f32 v88, v88
    v_exp_f32 v89, v89
    v_smfmac_f32_32x32x32_bf16 v[16:31], v[44:47], v[112:119], v8
    ds_read_b128 v[72:75], v13 offset:10240
    v_exp_f32 v90, v90
    v_exp_f32 v91, v91
    v_exp_f32 v92, v92
    v_exp_f32 v93, v93
    v_mfma_f32_32x32x16_bf16 v[104:119], v[80:83], v[48:51], v[52:67]
    s_waitcnt lgkmcnt(1)
    v_exp_f32 v94, v94
    v_exp_f32 v95, v95
    v_exp_f32 v96, v96
    v_exp_f32 v97, v97
    v_exp_f32 v98, v98
    v_smfmac_f32_32x32x32_bf16 v[16:31], v[32:35], v[88:95], v8
    s_mov_b64 exec, s[40:41]
    ds_read_b128 v[40:43], v13 offset:7168
    ds_read_b128 v[44:47], v13 offset:7424
    s_mov_b64 exec, -1
    v_exp_f32 v99, v99
    v_exp_f32 v100, v100
    v_exp_f32 v101, v101
    v_exp_f32 v102, v102
    v_exp_f32 v103, v103
    v_exp_f32 v104, v104
    v_exp_f32 v105, v105
    v_smfmac_f32_32x32x32_bf16 v[16:31], v[36:39], v[96:103], v8
    ds_read_b128 v[76:79], v13 offset:12288
    v_exp_f32 v106, v106
    v_exp_f32 v107, v107
    v_exp_f32 v108, v108
    v_exp_f32 v109, v109
    v_mfma_f32_32x32x16_bf16 v[88:103], v[68:71], v[48:51], v[52:67]
    s_waitcnt lgkmcnt(1)
    v_exp_f32 v110, v110
    v_exp_f32 v111, v111
    v_exp_f32 v112, v112
    v_exp_f32 v113, v113
    v_exp_f32 v114, v114
    v_smfmac_f32_32x32x32_bf16 v[16:31], v[40:43], v[104:111], v8
    s_mov_b64 exec, s[40:41]
    ds_read_b128 v[32:35], v13 offset:9216
    ds_read_b128 v[36:39], v13 offset:9472
    s_mov_b64 exec, -1
    v_exp_f32 v115, v115
    v_exp_f32 v116, v116
    v_exp_f32 v117, v117
    v_exp_f32 v118, v118
    v_exp_f32 v119, v119
    v_exp_f32 v88, v88
    v_exp_f32 v89, v89
    v_smfmac_f32_32x32x32_bf16 v[16:31], v[44:47], v[112:119], v8
    ds_read_b128 v[80:83], v13 offset:14336
    v_exp_f32 v90, v90
    v_exp_f32 v91, v91
    v_exp_f32 v92, v92
    v_exp_f32 v93, v93
    v_mfma_f32_32x32x16_bf16 v[104:119], v[72:75], v[48:51], v[52:67]
    s_waitcnt lgkmcnt(1)
    v_exp_f32 v94, v94
    v_exp_f32 v95, v95
    v_exp_f32 v96, v96
    v_exp_f32 v97, v97
    v_exp_f32 v98, v98
    v_smfmac_f32_32x32x32_bf16 v[16:31], v[32:35], v[88:95], v8
    s_mov_b64 exec, s[40:41]
    ds_read_b128 v[40:43], v13 offset:11264
    ds_read_b128 v[44:47], v13 offset:11520
    s_mov_b64 exec, -1
    v_exp_f32 v99, v99
    v_exp_f32 v100, v100
    v_exp_f32 v101, v101
    v_exp_f32 v102, v102
    v_exp_f32 v103, v103
    v_exp_f32 v104, v104
    v_exp_f32 v105, v105
    v_smfmac_f32_32x32x32_bf16 v[16:31], v[36:39], v[96:103], v8
    ds_read_b128 v[68:71], v13 offset:16384
    v_exp_f32 v106, v106
    v_exp_f32 v107, v107
    v_exp_f32 v108, v108
    v_exp_f32 v109, v109
    v_mfma_f32_32x32x16_bf16 v[88:103], v[76:79], v[48:51], v[52:67]
    s_waitcnt lgkmcnt(1)
    v_exp_f32 v110, v110
    v_exp_f32 v111, v111
    v_exp_f32 v112, v112
    v_exp_f32 v113, v113
    v_exp_f32 v114, v114
    v_smfmac_f32_32x32x32_bf16 v[16:31], v[40:43], v[104:111], v8
    s_mov_b64 exec, s[40:41]
    ds_read_b128 v[32:35], v13 offset:13312
    ds_read_b128 v[36:39], v13 offset:13568
    s_mov_b64 exec, -1
    v_exp_f32 v115, v115
    v_exp_f32 v116, v116
    v_exp_f32 v117, v117
    v_exp_f32 v118, v118
    v_exp_f32 v119, v119
    v_exp_f32 v88, v88
    v_exp_f32 v89, v89
    v_smfmac_f32_32x32x32_bf16 v[16:31], v[44:47], v[112:119], v8
    ds_read_b128 v[72:75], v13 offset:18432
    v_exp_f32 v90, v90
    v_exp_f32 v91, v91
    v_exp_f32 v92, v92
    v_exp_f32 v93, v93
    v_mfma_f32_32x32x16_bf16 v[104:119], v[80:83], v[48:51], v[52:67]
    s_waitcnt lgkmcnt(1)
    v_exp_f32 v94, v94
    v_exp_f32 v95, v95
    v_exp_f32 v96, v96
    v_exp_f32 v97, v97
    v_exp_f32 v98, v98
    v_smfmac_f32_32x32x32_bf16 v[16:31], v[32:35], v[88:95], v8
    s_mov_b64 exec, s[40:41]
    ds_read_b128 v[40:43], v13 offset:15360
    ds_read_b128 v[44:47], v13 offset:15616
    s_mov_b64 exec, -1
    v_exp_f32 v99, v99
    v_exp_f32 v100, v100
    v_exp_f32 v101, v101
    v_exp_f32 v102, v102
    v_exp_f32 v103, v103
    v_exp_f32 v104, v104
    v_exp_f32 v105, v105
    v_smfmac_f32_32x32x32_bf16 v[16:31], v[36:39], v[96:103], v8
    ds_read_b128 v[76:79], v13 offset:20480
    v_exp_f32 v106, v106
    v_exp_f32 v107, v107
    v_exp_f32 v108, v108
    v_exp_f32 v109, v109
    v_mfma_f32_32x32x16_bf16 v[88:103], v[68:71], v[48:51], v[52:67]
    s_waitcnt lgkmcnt(1)
    v_exp_f32 v110, v110
    v_exp_f32 v111, v111
    v_exp_f32 v112, v112
    v_exp_f32 v113, v113
    v_exp_f32 v114, v114
    v_smfmac_f32_32x32x32_bf16 v[16:31], v[40:43], v[104:111], v8
    s_mov_b64 exec, s[40:41]
    ds_read_b128 v[32:35], v13 offset:17408
    ds_read_b128 v[36:39], v13 offset:17664
    s_mov_b64 exec, -1
    v_add_u32 v13, 16384, v13
    s_sub_u32 s60, s60, 1
    s_cmp_lg_u32 s60, 0
    v_exp_f32 v115, v115
    v_exp_f32 v116, v116
    v_exp_f32 v117, v117
    v_exp_f32 v118, v118
    v_exp_f32 v119, v119
    s_cbranch_scc1 ATT_LOOP
    s_waitcnt lgkmcnt(0)
    s_nop 1
    v_smfmac_f32_32x32x32_bf16 v[16:31], v[44:47], v[112:119], v8
    s_lshl_b32 s34, s76, 1
    s_and_b32 s61, s30, 1
    s_add_u32 s34, s34, s61
    s_lshl_b32 s63, s34, 15
    s_add_u32 s34, s63, 2098176
    s_lshl_b32 s61, s77, 7
    s_add_u32 s63, s63, s61
    s_and_b32 s61, s30, 2
    s_lshl_b32 s61, s61, 5
    s_add_u32 s63, s63, s61
    s_add_u32 s62, s96, 2097152
    s_waitcnt vmcnt(0)
    s_nop 1
    v_rcp_f32 v11, v24
    s_nop 0
    v_mul_f32 v11, v11, v163
    v_mul_f32 v16, v16, v11
    v_mul_f32 v17, v17, v11
    v_mul_f32 v18, v18, v11
    v_mul_f32 v19, v19, v11
    v_mul_f32 v20, v20, v11
    v_mul_f32 v21, v21, v11
    v_mul_f32 v22, v22, v11
    v_mul_f32 v23, v23, v11
    v_cvt_pk_bf16_f32 v164, v16, v17
    v_cvt_pk_bf16_f32 v165, v18, v19
    v_cvt_pk_bf16_f32 v166, v20, v21
    v_cvt_pk_bf16_f32 v167, v22, v23
    buffer_store_dwordx4 v[164:167], v2, s[48:51], s62 offen sc1
    s_cmp_lt_u32 s30, 4
    s_cbranch_scc1 FINISH
    s_barrier
    s_barrier
    s_branch A_DONE
FINISH:
    v_bfe_u32 v11, v1, 2, 2
    v_lshrrev_b32 v12, 5, v1
    v_lshl_add_u32 v161, v12, 2, v11
    v_lshlrev_b32 v161, 7, v161
    v_bfe_u32 v12, v1, 4, 1
    v_lshl_add_u32 v161, v12, 5, v161
    v_and_b32 v12, 3, v1
    v_lshl_add_u32 v161, v12, 3, v161
    v_bfe_u32 v12, v1, 3, 1
    v_lshlrev_b32 v12, 6, v12
    v_add_u32 v161, v161, v12
    v_xor_b32 v162, 64, v161
    s_and_b32 s60, s30, 2
    s_lshl_b32 s60, s60, 5
    v_xor_b32 v161, s60, v161
    v_add_u32 v161, 131072, v161
    v_lshrrev_b32 v11, 5, v1
    v_lshlrev_b32 v10, 10, v10
    v_lshl_add_u32 v10, v11, 4, v10
    s_lshl_b32 s60, s30, 12
    v_add_u32 v6, s60, v2
    s_mov_b32 s35, 15
    s_setprio 3
    s_barrier
    s_add_u32 s60, s34, 0
    buffer_load_dwordx4 v[96:99], v2, s[48:51], s60 offen sc1
    s_add_u32 s60, s34, 8192
    buffer_load_dwordx4 v[100:103], v2, s[48:51], s60 offen sc1
    s_add_u32 s60, s34, 16384
    buffer_load_dwordx4 v[104:107], v2, s[48:51], s60 offen sc1
    s_add_u32 s60, s34, 24576
    buffer_load_dwordx4 v[108:111], v2, s[48:51], s60 offen sc1
    s_add_u32 s60, s34, 2048
    buffer_load_dwordx4 v[112:115], v2, s[48:51], s60 offen sc1
    s_add_u32 s60, s34, 10240
    buffer_load_dwordx4 v[116:119], v2, s[48:51], s60 offen sc1
    s_add_u32 s60, s34, 18432
    buffer_load_dwordx4 v[120:123], v2, s[48:51], s60 offen sc1
    s_add_u32 s60, s34, 26624
    buffer_load_dwordx4 v[124:127], v2, s[48:51], s60 offen sc1
    s_barrier
    ds_read_b128 v[16:19], v6 offset:0
    ds_read_b128 v[20:23], v6 offset:1024
    ds_read_b128 v[24:27], v6 offset:2048
    ds_read_b128 v[28:31], v6 offset:3072
    ds_read_b128 v[32:35], v6 offset:16384
    ds_read_b128 v[36:39], v6 offset:17408
    ds_read_b128 v[40:43], v6 offset:18432
    ds_read_b128 v[44:47], v6 offset:19456
    ds_read_b128 v[48:51], v6 offset:32768
    ds_read_b128 v[52:55], v6 offset:33792
    ds_read_b128 v[56:59], v6 offset:34816
    ds_read_b128 v[60:63], v6 offset:35840
    ds_read_b128 v[64:67], v6 offset:49152
    ds_read_b128 v[68:71], v6 offset:50176
    ds_read_b128 v[72:75], v6 offset:51200
    ds_read_b128 v[76:79], v6 offset:52224
    s_add_u32 s60, s34, 4096
    buffer_load_dwordx4 v[128:131], v2, s[48:51], s60 offen sc1
    s_add_u32 s60, s34, 12288
    buffer_load_dwordx4 v[132:135], v2, s[48:51], s60 offen sc1
    s_add_u32 s60, s34, 20480
    buffer_load_dwordx4 v[136:139], v2, s[48:51], s60 offen sc1
    s_add_u32 s60, s34, 28672
    buffer_load_dwordx4 v[140:143], v2, s[48:51], s60 offen sc1
    s_add_u32 s60, s34, 6144
    buffer_load_dwordx4 v[144:147], v2, s[48:51], s60 offen sc1
    s_add_u32 s60, s34, 14336
    buffer_load_dwordx4 v[148:151], v2, s[48:51], s60 offen sc1
    s_add_u32 s60, s34, 22528
    buffer_load_dwordx4 v[152:155], v2, s[48:51], s60 offen sc1
    s_add_u32 s60, s34, 30720
    buffer_load_dwordx4 v[156:159], v2, s[48:51], s60 offen sc1
    s_waitcnt lgkmcnt(0)
    ds_read_b64_tr_b16 v[80:81], v161 offset:6144
    ds_read_b64_tr_b16 v[82:83], v161 offset:7168
    ds_read_b64_tr_b16 v[84:85], v161 offset:14336
    ds_read_b64_tr_b16 v[86:87], v161 offset:15360
    ds_read_b64_tr_b16 v[88:89], v161 offset:22528
    ds_read_b64_tr_b16 v[90:91], v161 offset:23552
    ds_read_b64_tr_b16 v[92:93], v161 offset:30720
    ds_read_b64_tr_b16 v[94:95], v161 offset:31744
    v_pk_add_f32 v[16:17], v[16:17], v[32:33]
    v_pk_add_f32 v[18:19], v[18:19], v[34:35]
    v_pk_add_f32 v[20:21], v[20:21], v[36:37]
    v_pk_add_f32 v[22:23], v[22:23], v[38:39]
    v_pk_add_f32 v[24:25], v[24:25], v[40:41]
    v_pk_add_f32 v[26:27], v[26:27], v[42:43]
    v_pk_add_f32 v[28:29], v[28:29], v[44:45]
    v_pk_add_f32 v[30:31], v[30:31], v[46:47]
    ds_read_b64_tr_b16 v[32:33], v161 offset:0
    ds_read_b64_tr_b16 v[34:35], v161 offset:1024
    ds_read_b64_tr_b16 v[36:37], v161 offset:8192
    ds_read_b64_tr_b16 v[38:39], v161 offset:9216
    ds_read_b64_tr_b16 v[40:41], v161 offset:16384
    ds_read_b64_tr_b16 v[42:43], v161 offset:17408
    ds_read_b64_tr_b16 v[44:45], v161 offset:24576
    ds_read_b64_tr_b16 v[46:47], v161 offset:25600
    v_pk_add_f32 v[16:17], v[16:17], v[48:49]
    v_pk_add_f32 v[18:19], v[18:19], v[50:51]
    v_pk_add_f32 v[20:21], v[20:21], v[52:53]
    v_pk_add_f32 v[22:23], v[22:23], v[54:55]
    v_pk_add_f32 v[24:25], v[24:25], v[56:57]
    v_pk_add_f32 v[26:27], v[26:27], v[58:59]
    v_pk_add_f32 v[28:29], v[28:29], v[60:61]
    v_pk_add_f32 v[30:31], v[30:31], v[62:63]
    ds_read_b64_tr_b16 v[48:49], v161 offset:2048
    ds_read_b64_tr_b16 v[50:51], v161 offset:3072
    ds_read_b64_tr_b16 v[52:53], v161 offset:10240
    ds_read_b64_tr_b16 v[54:55], v161 offset:11264
    ds_read_b64_tr_b16 v[56:57], v161 offset:18432
    ds_read_b64_tr_b16 v[58:59], v161 offset:19456
    ds_read_b64_tr_b16 v[60:61], v161 offset:26624
    ds_read_b64_tr_b16 v[62:63], v161 offset:27648
    v_pk_add_f32 v[16:17], v[16:17], v[64:65]
    v_pk_add_f32 v[18:19], v[18:19], v[66:67]
    v_pk_add_f32 v[20:21], v[20:21], v[68:69]
    v_pk_add_f32 v[22:23], v[22:23], v[70:71]
    v_pk_add_f32 v[24:25], v[24:25], v[72:73]
    v_pk_add_f32 v[26:27], v[26:27], v[74:75]
    v_pk_add_f32 v[28:29], v[28:29], v[76:77]
    v_pk_add_f32 v[30:31], v[30:31], v[78:79]
    ds_read_b64_tr_b16 v[64:65], v161 offset:4096
    ds_read_b64_tr_b16 v[66:67], v161 offset:5120
    ds_read_b64_tr_b16 v[68:69], v161 offset:12288
    ds_read_b64_tr_b16 v[70:71], v161 offset:13312
    ds_read_b64_tr_b16 v[72:73], v161 offset:20480
    ds_read_b64_tr_b16 v[74:75], v161 offset:21504
    ds_read_b64_tr_b16 v[76:77], v161 offset:28672
    ds_read_b64_tr_b16 v[78:79], v161 offset:29696
    s_waitcnt lgkmcnt(0)
    s_waitcnt vmcnt(12)
    v_max_u32 v11, v96, v97
    v_max3_u32 v11, v11, v98, v99
    v_max3_u32 v11, v11, v100, v101
    v_max3_u32 v11, v11, v102, v103
    v_max3_u32 v11, v11, v104, v105
    v_max3_u32 v11, v11, v106, v107
    v_max3_u32 v11, v11, v108, v109
    v_max3_u32 v11, v11, v110, v111
    v_cmp_eq_u32 vcc, -1, v11
    s_cmp_eq_u32 s100, 0
    s_cbranch_scc1 OGOA0
    s_nop 2
    s_cbranch_vccnz ONEXTA0
OGOA0:
    v_mfma_f32_32x32x16_bf16 v[16:31], v[32:35], v[96:99], v[16:31]
    v_mfma_f32_32x32x16_bf16 v[16:31], v[36:39], v[100:103], v[16:31]
    v_mfma_f32_32x32x16_bf16 v[16:31], v[40:43], v[104:107], v[16:31]
    v_mfma_f32_32x32x16_bf16 v[16:31], v[44:47], v[108:111], v[16:31]
    s_bitset0_b32 s35, 0
ONEXTA0:
    s_waitcnt vmcnt(8)
    v_max_u32 v11, v112, v113
    v_max3_u32 v11, v11, v114, v115
    v_max3_u32 v11, v11, v116, v117
    v_max3_u32 v11, v11, v118, v119
    v_max3_u32 v11, v11, v120, v121
    v_max3_u32 v11, v11, v122, v123
    v_max3_u32 v11, v11, v124, v125
    v_max3_u32 v11, v11, v126, v127
    v_cmp_eq_u32 vcc, -1, v11
    s_cmp_eq_u32 s100, 0
    s_cbranch_scc1 OGOA1
    s_nop 2
    s_cbranch_vccnz ONEXTA1
OGOA1:
    v_mfma_f32_32x32x16_bf16 v[16:31], v[48:51], v[112:115], v[16:31]
    v_mfma_f32_32x32x16_bf16 v[16:31], v[52:55], v[116:119], v[16:31]
    v_mfma_f32_32x32x16_bf16 v[16:31], v[56:59], v[120:123], v[16:31]
    v_mfma_f32_32x32x16_bf16 v[16:31], v[60:63], v[124:127], v[16:31]
    s_bitset0_b32 s35, 1
ONEXTA1:
    s_waitcnt vmcnt(4)
    v_max_u32 v11, v128, v129
    v_max3_u32 v11, v11, v130, v131
    v_max3_u32 v11, v11, v132, v133
    v_max3_u32 v11, v11, v134, v135
    v_max3_u32 v11, v11, v136, v137
    v_max3_u32 v11, v11, v138, v139
    v_max3_u32 v11, v11, v140, v141
    v_max3_u32 v11, v11, v142, v143
    v_cmp_eq_u32 vcc, -1, v11
    s_cmp_eq_u32 s100, 0
    s_cbranch_scc1 OGOA2
    s_nop 2
    s_cbranch_vccnz ONEXTA2
OGOA2:
    v_mfma_f32_32x32x16_bf16 v[16:31], v[64:67], v[128:131], v[16:31]
    v_mfma_f32_32x32x16_bf16 v[16:31], v[68:71], v[132:135], v[16:31]
    v_mfma_f32_32x32x16_bf16 v[16:31], v[72:75], v[136:139], v[16:31]
    v_mfma_f32_32x32x16_bf16 v[16:31], v[76:79], v[140:143], v[16:31]
    s_bitset0_b32 s35, 2
ONEXTA2:
    s_waitcnt vmcnt(0)
    v_max_u32 v11, v144, v145
    v_max3_u32 v11, v11, v146, v147
    v_max3_u32 v11, v11, v148, v149
    v_max3_u32 v11, v11, v150, v151
    v_max3_u32 v11, v11, v152, v153
    v_max3_u32 v11, v11, v154, v155
    v_max3_u32 v11, v11, v156, v157
    v_max3_u32 v11, v11, v158, v159
    v_cmp_eq_u32 vcc, -1, v11
    s_cmp_eq_u32 s100, 0
    s_cbranch_scc1 OGOA3
    s_nop 2
    s_cbranch_vccnz ONEXTA3
OGOA3:
    v_mfma_f32_32x32x16_bf16 v[16:31], v[80:83], v[144:147], v[16:31]
    v_mfma_f32_32x32x16_bf16 v[16:31], v[84:87], v[148:151], v[16:31]
    v_mfma_f32_32x32x16_bf16 v[16:31], v[88:91], v[152:155], v[16:31]
    v_mfma_f32_32x32x16_bf16 v[16:31], v[92:95], v[156:159], v[16:31]
    s_bitset0_b32 s35, 3
ONEXTA3:
    s_cmp_eq_u32 s35, 0
    s_cbranch_scc1 ODONE
OLOOP:
    s_sub_u32 s100, s100, 1
    s_bitcmp0_b32 s35, 0
    s_cbranch_scc1 OSK0
    s_add_u32 s60, s34, 0
    buffer_load_dwordx4 v[96:99], v2, s[48:51], s60 offen sc1
    s_add_u32 s60, s34, 8192
    buffer_load_dwordx4 v[100:103], v2, s[48:51], s60 offen sc1
    s_add_u32 s60, s34, 16384
    buffer_load_dwordx4 v[104:107], v2, s[48:51], s60 offen sc1
    s_add_u32 s60, s34, 24576
    buffer_load_dwordx4 v[108:111], v2, s[48:51], s60 offen sc1
OSK0:
    s_bitcmp0_b32 s35, 1
    s_cbranch_scc1 OSK1
    s_add_u32 s60, s34, 2048
    buffer_load_dwordx4 v[112:115], v2, s[48:51], s60 offen sc1
    s_add_u32 s60, s34, 10240
    buffer_load_dwordx4 v[116:119], v2, s[48:51], s60 offen sc1
    s_add_u32 s60, s34, 18432
    buffer_load_dwordx4 v[120:123], v2, s[48:51], s60 offen sc1
    s_add_u32 s60, s34, 26624
    buffer_load_dwordx4 v[124:127], v2, s[48:51], s60 offen sc1
OSK1:
    s_bitcmp0_b32 s35, 2
    s_cbranch_scc1 OSK2
    s_add_u32 s60, s34, 4096
    buffer_load_dwordx4 v[128:131], v2, s[48:51], s60 offen sc1
    s_add_u32 s60, s34, 12288
    buffer_load_dwordx4 v[132:135], v2, s[48:51], s60 offen sc1
    s_add_u32 s60, s34, 20480
    buffer_load_dwordx4 v[136:139], v2, s[48:51], s60 offen sc1
    s_add_u32 s60, s34, 28672
    buffer_load_dwordx4 v[140:143], v2, s[48:51], s60 offen sc1
OSK2:
    s_bitcmp0_b32 s35, 3
    s_cbranch_scc1 OSK3
    s_add_u32 s60, s34, 6144
    buffer_load_dwordx4 v[144:147], v2, s[48:51], s60 offen sc1
    s_add_u32 s60, s34, 14336
    buffer_load_dwordx4 v[148:151], v2, s[48:51], s60 offen sc1
    s_add_u32 s60, s34, 22528
    buffer_load_dwordx4 v[152:155], v2, s[48:51], s60 offen sc1
    s_add_u32 s60, s34, 30720
    buffer_load_dwordx4 v[156:159], v2, s[48:51], s60 offen sc1
OSK3:
    s_waitcnt vmcnt(0)
    s_bitcmp0_b32 s35, 0
    s_cbranch_scc1 ONEXTB0
    v_max_u32 v11, v96, v97
    v_max3_u32 v11, v11, v98, v99
    v_max3_u32 v11, v11, v100, v101
    v_max3_u32 v11, v11, v102, v103
    v_max3_u32 v11, v11, v104, v105
    v_max3_u32 v11, v11, v106, v107
    v_max3_u32 v11, v11, v108, v109
    v_max3_u32 v11, v11, v110, v111
    v_cmp_eq_u32 vcc, -1, v11
    s_cmp_eq_u32 s100, 0
    s_cbranch_scc1 OGOB0
    s_nop 2
    s_cbranch_vccnz ONEXTB0
OGOB0:
    v_mfma_f32_32x32x16_bf16 v[16:31], v[32:35], v[96:99], v[16:31]
    v_mfma_f32_32x32x16_bf16 v[16:31], v[36:39], v[100:103], v[16:31]
    v_mfma_f32_32x32x16_bf16 v[16:31], v[40:43], v[104:107], v[16:31]
    v_mfma_f32_32x32x16_bf16 v[16:31], v[44:47], v[108:111], v[16:31]
    s_bitset0_b32 s35, 0
ONEXTB0:
    s_bitcmp0_b32 s35, 1
    s_cbranch_scc1 ONEXTB1
    v_max_u32 v11, v112, v113
    v_max3_u32 v11, v11, v114, v115
    v_max3_u32 v11, v11, v116, v117
    v_max3_u32 v11, v11, v118, v119
    v_max3_u32 v11, v11, v120, v121
    v_max3_u32 v11, v11, v122, v123
    v_max3_u32 v11, v11, v124, v125
    v_max3_u32 v11, v11, v126, v127
    v_cmp_eq_u32 vcc, -1, v11
    s_cmp_eq_u32 s100, 0
    s_cbranch_scc1 OGOB1
    s_nop 2
    s_cbranch_vccnz ONEXTB1
OGOB1:
    v_mfma_f32_32x32x16_bf16 v[16:31], v[48:51], v[112:115], v[16:31]
    v_mfma_f32_32x32x16_bf16 v[16:31], v[52:55], v[116:119], v[16:31]
    v_mfma_f32_32x32x16_bf16 v[16:31], v[56:59], v[120:123], v[16:31]
    v_mfma_f32_32x32x16_bf16 v[16:31], v[60:63], v[124:127], v[16:31]
    s_bitset0_b32 s35, 1
ONEXTB1:
    s_bitcmp0_b32 s35, 2
    s_cbranch_scc1 ONEXTB2
    v_max_u32 v11, v128, v129
    v_max3_u32 v11, v11, v130, v131
    v_max3_u32 v11, v11, v132, v133
    v_max3_u32 v11, v11, v134, v135
    v_max3_u32 v11, v11, v136, v137
    v_max3_u32 v11, v11, v138, v139
    v_max3_u32 v11, v11, v140, v141
    v_max3_u32 v11, v11, v142, v143
    v_cmp_eq_u32 vcc, -1, v11
    s_cmp_eq_u32 s100, 0
    s_cbranch_scc1 OGOB2
    s_nop 2
    s_cbranch_vccnz ONEXTB2
OGOB2:
    v_mfma_f32_32x32x16_bf16 v[16:31], v[64:67], v[128:131], v[16:31]
    v_mfma_f32_32x32x16_bf16 v[16:31], v[68:71], v[132:135], v[16:31]
    v_mfma_f32_32x32x16_bf16 v[16:31], v[72:75], v[136:139], v[16:31]
    v_mfma_f32_32x32x16_bf16 v[16:31], v[76:79], v[140:143], v[16:31]
    s_bitset0_b32 s35, 2
ONEXTB2:
    s_bitcmp0_b32 s35, 3
    s_cbranch_scc1 ONEXTB3
    v_max_u32 v11, v144, v145
    v_max3_u32 v11, v11, v146, v147
    v_max3_u32 v11, v11, v148, v149
    v_max3_u32 v11, v11, v150, v151
    v_max3_u32 v11, v11, v152, v153
    v_max3_u32 v11, v11, v154, v155
    v_max3_u32 v11, v11, v156, v157
    v_max3_u32 v11, v11, v158, v159
    v_cmp_eq_u32 vcc, -1, v11
    s_cmp_eq_u32 s100, 0
    s_cbranch_scc1 OGOB3
    s_nop 2
    s_cbranch_vccnz ONEXTB3
OGOB3:
    v_mfma_f32_32x32x16_bf16 v[16:31], v[80:83], v[144:147], v[16:31]
    v_mfma_f32_32x32x16_bf16 v[16:31], v[84:87], v[148:151], v[16:31]
    v_mfma_f32_32x32x16_bf16 v[16:31], v[88:91], v[152:155], v[16:31]
    v_mfma_f32_32x32x16_bf16 v[16:31], v[92:95], v[156:159], v[16:31]
    s_bitset0_b32 s35, 3
ONEXTB3:
    s_cmp_lg_u32 s35, 0
    s_cbranch_scc1 OLOOP
ODONE:
    s_nop 11
    v_cvt_pk_bf16_f32 v32, v16, v17
    v_cvt_pk_bf16_f32 v33, v18, v19
    v_cvt_pk_bf16_f32 v34, v20, v21
    v_cvt_pk_bf16_f32 v35, v22, v23
    v_cvt_pk_bf16_f32 v36, v24, v25
    v_cvt_pk_bf16_f32 v37, v26, v27
    v_cvt_pk_bf16_f32 v38, v28, v29
    v_cvt_pk_bf16_f32 v39, v30, v31
    s_nop 1
    v_permlane32_swap_b32 v32, v34
    v_permlane32_swap_b32 v33, v35
    v_permlane32_swap_b32 v36, v38
    v_permlane32_swap_b32 v37, v39
    buffer_store_dwordx4 v[32:35], v10, s[52:55], s63 offen
    buffer_store_dwordx4 v[36:39], v10, s[52:55], s63 offen offset:32
A_DONE:
K_END:
    s_endpgm
SP_HELPER:
    v_mov_b32 v16, 0
    s_mov_b32 s48, s28
    s_mov_b32 s49, s29
    s_mov_b32 s50, 16777216
    s_mov_b32 s51, 0x00020000
    s_mov_b32 s72, s26
    s_mov_b32 s73, s27
    s_mov_b32 s74, 256
    s_mov_b32 s75, 0x00020000
    s_waitcnt vmcnt(0)
    s_barrier
    s_mov_b32 s36, s22
    s_mov_b32 s37, s23
    s_mov_b32 s38, 1024
    s_mov_b32 s39, 0x00020000
    s_mov_b32 m0, 98304
    v_lshrrev_b32 v7, 2, v1
    buffer_load_dwordx4 v2, s[36:39], 0 offen lds
    v_and_b32 v8, 3, v1
    v_lshlrev_b32 v8, 4, v8
    v_lshl_add_u32 v9, v7, 10, v8
    s_mov_b32 s40, s6
    s_mov_b32 s41, s7
    s_mov_b32 s42, 524288
    s_mov_b32 s43, 0x00020000
    s_lshl_b32 s60, s3, 17
    s_lshl_b32 s62, s56, 6
    s_add_u32 s60, s60, s62
    s_lshl_b32 s61, s3, 13
    s_add_u32 m0, s61, 131072
    s_nop 0
    buffer_load_dwordx4 v9, s[40:43], s60 offen lds
    s_add_u32 m0, s61, 132096
    s_add_u32 s60, s60, 16384
    buffer_load_dwordx4 v9, s[40:43], s60 offen lds
    s_add_u32 m0, s61, 133120
    s_add_u32 s60, s60, 16384
    buffer_load_dwordx4 v9, s[40:43], s60 offen lds
    s_add_u32 m0, s61, 134144
    s_add_u32 s60, s60, 16384
    buffer_load_dwordx4 v9, s[40:43], s60 offen lds
    s_add_u32 m0, s61, 135168
    s_add_u32 s60, s60, 16384
    buffer_load_dwordx4 v9, s[40:43], s60 offen lds
    s_add_u32 m0, s61, 136192
    s_add_u32 s60, s60, 16384
    buffer_load_dwordx4 v9, s[40:43], s60 offen lds
    s_add_u32 m0, s61, 137216
    s_add_u32 s60, s60, 16384
    buffer_load_dwordx4 v9, s[40:43], s60 offen lds
    s_add_u32 m0, s61, 138240
    s_add_u32 s60, s60, 16384
    buffer_load_dwordx4 v9, s[40:43], s60 offen lds
    s_lshl_b32 s60, s97, 9
    s_lshl_b32 s61, s3, 7
    s_add_u32 s60, s60, s61
    s_add_u32 s60, s60, 4337664
    s_mov_b64 exec, 0xff
    buffer_store_dword v16, v3, s[48:51], s60 offen sc1
    s_mov_b64 exec, -1
    v_mov_b32 v12, -1
    v_mov_b32 v13, -1
    v_mov_b32 v14, -1
    v_mov_b32 v15, -1
    s_xor_b32 s63, s97, 1
    s_lshl_b32 s63, s63, 16
    s_waitcnt vmcnt(0)
    s_barrier
    s_cmp_lg_u32 s3, 3
    s_cbranch_scc1 SPH_A
    v_mov_b32 v21, 1
    v_mov_b32 v17, 0
    s_mov_b64 exec, 1
    buffer_atomic_add v21, v17, s[72:75], 0 offen offset:0 sc0 sc1
    s_waitcnt vmcnt(0)
    v_readfirstlane_b32 s60, v21
    s_nop 3
    s_cmp_lt_u32 s60, 31
    s_cbranch_scc1 ARR_13
    buffer_store_dword v21, v17, s[72:75], 0 offen offset:128 sc1
ARR_13:
    s_mov_b64 exec, -1
SPH_A:
    s_lshl_b32 s60, s97, 16
    s_lshl_b32 s61, s3, 14
    s_add_u32 s60, s60, s61
    s_add_u32 s60, s60, 2097152
    s_add_u32 s61, s60, 0
    buffer_store_dwordx4 v[12:15], v2, s[48:51], s61 offen offset:0 sc1
    buffer_store_dwordx4 v[12:15], v2, s[48:51], s61 offen offset:1024 sc1
    buffer_store_dwordx4 v[12:15], v2, s[48:51], s61 offen offset:2048 sc1
    buffer_store_dwordx4 v[12:15], v2, s[48:51], s61 offen offset:3072 sc1
    s_add_u32 s61, s60, 4096
    buffer_store_dwordx4 v[12:15], v2, s[48:51], s61 offen offset:0 sc1
    buffer_store_dwordx4 v[12:15], v2, s[48:51], s61 offen offset:1024 sc1
    buffer_store_dwordx4 v[12:15], v2, s[48:51], s61 offen offset:2048 sc1
    buffer_store_dwordx4 v[12:15], v2, s[48:51], s61 offen offset:3072 sc1
    s_add_u32 s61, s60, 8192
    buffer_store_dwordx4 v[12:15], v2, s[48:51], s61 offen offset:0 sc1
    buffer_store_dwordx4 v[12:15], v2, s[48:51], s61 offen offset:1024 sc1
    buffer_store_dwordx4 v[12:15], v2, s[48:51], s61 offen offset:2048 sc1
    buffer_store_dwordx4 v[12:15], v2, s[48:51], s61 offen offset:3072 sc1
    s_add_u32 s61, s60, 12288
    buffer_store_dwordx4 v[12:15], v2, s[48:51], s61 offen offset:0 sc1
    buffer_store_dwordx4 v[12:15], v2, s[48:51], s61 offen offset:1024 sc1
    buffer_store_dwordx4 v[12:15], v2, s[48:51], s61 offen offset:2048 sc1
    buffer_store_dwordx4 v[12:15], v2, s[48:51], s61 offen offset:3072 sc1
    s_barrier
    s_lshl_b32 s62, s3, 1
    s_add_u32 s62, s62, 0
    s_lshl_b32 s60, s62, 7
    s_add_u32 s60, s60, s63
    s_lshl_b32 s61, s62, 13
    s_add_u32 s61, s61, 65536
    s_add_u32 m0, s61, 0
    s_nop 0
    buffer_load_dwordx4 v4, s[32:35], s60 offen lds
    s_add_u32 m0, s61, 1024
    s_add_u32 s60, s60, 8192
    buffer_load_dwordx4 v5, s[32:35], s60 offen lds
    s_add_u32 m0, s61, 2048
    s_add_u32 s60, s60, 8192
    buffer_load_dwordx4 v4, s[32:35], s60 offen lds
    s_add_u32 m0, s61, 3072
    s_add_u32 s60, s60, 8192
    buffer_load_dwordx4 v5, s[32:35], s60 offen lds
    s_add_u32 m0, s61, 4096
    s_add_u32 s60, s60, 8192
    buffer_load_dwordx4 v4, s[32:35], s60 offen lds
    s_add_u32 m0, s61, 5120
    s_add_u32 s60, s60, 8192
    buffer_load_dwordx4 v5, s[32:35], s60 offen lds
    s_add_u32 m0, s61, 6144
    s_add_u32 s60, s60, 8192
    buffer_load_dwordx4 v4, s[32:35], s60 offen lds
    s_add_u32 m0, s61, 7168
    s_add_u32 s60, s60, 8192
    buffer_load_dwordx4 v5, s[32:35], s60 offen lds
    s_lshl_b32 s62, s3, 1
    s_add_u32 s62, s62, 1
    s_lshl_b32 s60, s62, 7
    s_add_u32 s60, s60, s63
    s_lshl_b32 s61, s62, 13
    s_add_u32 s61, s61, 65536
    s_add_u32 m0, s61, 0
    s_nop 0
    buffer_load_dwordx4 v4, s[32:35], s60 offen lds
    s_add_u32 m0, s61, 1024
    s_add_u32 s60, s60, 8192
    buffer_load_dwordx4 v5, s[32:35], s60 offen lds
    s_add_u32 m0, s61, 2048
    s_add_u32 s60, s60, 8192
    buffer_load_dwordx4 v4, s[32:35], s60 offen lds
    s_add_u32 m0, s61, 3072
    s_add_u32 s60, s60, 8192
    buffer_load_dwordx4 v5, s[32:35], s60 offen lds
    s_add_u32 m0, s61, 4096
    s_add_u32 s60, s60, 8192
    buffer_load_dwordx4 v4, s[32:35], s60 offen lds
    s_add_u32 m0, s61, 5120
    s_add_u32 s60, s60, 8192
    buffer_load_dwordx4 v5, s[32:35], s60 offen lds
    s_add_u32 m0, s61, 6144
    s_add_u32 s60, s60, 8192
    buffer_load_dwordx4 v4, s[32:35], s60 offen lds
    s_add_u32 m0, s61, 7168
    s_add_u32 s60, s60, 8192
    buffer_load_dwordx4 v5, s[32:35], s60 offen lds
    s_waitcnt vmcnt(0)
    s_barrier
    s_cmp_lg_u32 s3, 3
    s_cbranch_scc1 SPH_C
    v_mov_b32 v21, 1
    v_mov_b32 v17, 0
    s_mov_b64 exec, 1
    buffer_atomic_add v21, v17, s[72:75], 0 offen offset:64 sc0 sc1
    s_waitcnt vmcnt(0)
    v_readfirstlane_b32 s60, v21
    s_nop 3
    s_cmp_lt_u32 s60, 31
    s_cbranch_scc1 ARR_14
    buffer_store_dword v21, v17, s[72:75], 0 offen offset:192 sc1
ARR_14:
    s_mov_b64 exec, -1
SPH_C:
    s_cmp_lg_u32 s3, 3
    s_cbranch_scc1 SPH_B
    v_mov_b32 v17, 0
SPIN_15:
    buffer_load_dword v20, v17, s[72:75], 0 offen offset:128 sc1
SPINC_16:
    s_waitcnt vmcnt(0)
    v_cmp_eq_u32 vcc, 0, v20
    s_nop 4
    s_cbranch_vccz SPIND_17
    s_cmp_eq_u32 s100, 0
    s_cbranch_scc1 SPIND_17
    s_sub_u32 s100, s100, 1
    s_sleep 4
    s_branch SPIN_15
SPIND_17:
SPH_B:
    s_waitcnt vmcnt(0)
    s_barrier
    s_barrier
    s_mov_b32 s59, 0x3020100
    s_lshl_b32 s62, s3, 3
    s_lshr_b32 s59, s59, s62
    s_and_b32 s59, s59, 15
    s_add_u32 s62, s59, s94
    s_and_b32 s62, s62, 7
    s_lshl_b32 s62, s62, 14
    s_add_u32 s62, s62, 4194304
    s_lshl_b32 s59, s59, 14
    s_add_u32 m0, s59, 0
    s_add_u32 s64, s62, 0
    buffer_load_dwordx4 v2, s[48:51], s64 offen offset:0 sc1 lds
    buffer_load_dwordx4 v2, s[48:51], s64 offen offset:1024 sc1 lds
    buffer_load_dwordx4 v2, s[48:51], s64 offen offset:2048 sc1 lds
    buffer_load_dwordx4 v2, s[48:51], s64 offen offset:3072 sc1 lds
    s_add_u32 m0, s59, 4096
    s_add_u32 s64, s62, 4096
    buffer_load_dwordx4 v2, s[48:51], s64 offen offset:0 sc1 lds
    buffer_load_dwordx4 v2, s[48:51], s64 offen offset:1024 sc1 lds
    buffer_load_dwordx4 v2, s[48:51], s64 offen offset:2048 sc1 lds
    buffer_load_dwordx4 v2, s[48:51], s64 offen offset:3072 sc1 lds
    s_add_u32 m0, s59, 8192
    s_add_u32 s64, s62, 8192
    buffer_load_dwordx4 v2, s[48:51], s64 offen offset:0 sc1 lds
    buffer_load_dwordx4 v2, s[48:51], s64 offen offset:1024 sc1 lds
    buffer_load_dwordx4 v2, s[48:51], s64 offen offset:2048 sc1 lds
    buffer_load_dwordx4 v2, s[48:51], s64 offen offset:3072 sc1 lds
    s_add_u32 m0, s59, 12288
    s_add_u32 s64, s62, 12288
    buffer_load_dwordx4 v2, s[48:51], s64 offen offset:0 sc1 lds
    buffer_load_dwordx4 v2, s[48:51], s64 offen offset:1024 sc1 lds
    buffer_load_dwordx4 v2, s[48:51], s64 offen offset:2048 sc1 lds
    buffer_load_dwordx4 v2, s[48:51], s64 offen offset:3072 sc1 lds
    s_mov_b32 s59, 0x7060504
    s_lshl_b32 s62, s3, 3
    s_lshr_b32 s59, s59, s62
    s_and_b32 s59, s59, 15
    s_add_u32 s62, s59, s94
    s_and_b32 s62, s62, 7
    s_lshl_b32 s62, s62, 14
    s_add_u32 s62, s62, 4194304
    s_lshl_b32 s59, s59, 14
    s_add_u32 m0, s59, 0
    s_add_u32 s64, s62, 0
    buffer_load_dwordx4 v2, s[48:51], s64 offen offset:0 sc1 lds
    buffer_load_dwordx4 v2, s[48:51], s64 offen offset:1024 sc1 lds
    buffer_load_dwordx4 v2, s[48:51], s64 offen offset:2048 sc1 lds
    buffer_load_dwordx4 v2, s[48:51], s64 offen offset:3072 sc1 lds
    s_add_u32 m0, s59, 4096
    s_add_u32 s64, s62, 4096
    buffer_load_dwordx4 v2, s[48:51], s64 offen offset:0 sc1 lds
    buffer_load_dwordx4 v2, s[48:51], s64 offen offset:1024 sc1 lds
    buffer_load_dwordx4 v2, s[48:51], s64 offen offset:2048 sc1 lds
    buffer_load_dwordx4 v2, s[48:51], s64 offen offset:3072 sc1 lds
    s_add_u32 m0, s59, 8192
    s_add_u32 s64, s62, 8192
    buffer_load_dwordx4 v2, s[48:51], s64 offen offset:0 sc1 lds
    buffer_load_dwordx4 v2, s[48:51], s64 offen offset:1024 sc1 lds
    buffer_load_dwordx4 v2, s[48:51], s64 offen offset:2048 sc1 lds
    buffer_load_dwordx4 v2, s[48:51], s64 offen offset:3072 sc1 lds
    s_add_u32 m0, s59, 12288
    s_add_u32 s64, s62, 12288
    buffer_load_dwordx4 v2, s[48:51], s64 offen offset:0 sc1 lds
    buffer_load_dwordx4 v2, s[48:51], s64 offen offset:1024 sc1 lds
    buffer_load_dwordx4 v2, s[48:51], s64 offen offset:2048 sc1 lds
    buffer_load_dwordx4 v2, s[48:51], s64 offen offset:3072 sc1 lds
    s_cmp_lg_u32 s3, 3
    s_cbranch_scc1 SPH_D
    v_mov_b32 v17, 0
SPIN_18:
    buffer_load_dword v20, v17, s[72:75], 0 offen offset:192 sc1
SPINC_19:
    s_waitcnt vmcnt(0)
    v_cmp_eq_u32 vcc, 0, v20
    s_nop 4
    s_cbranch_vccz SPIND_20
    s_cmp_eq_u32 s100, 0
    s_cbranch_scc1 SPIND_20
    s_sub_u32 s100, s100, 1
    s_sleep 4
    s_branch SPIN_18
SPIND_20:
SPH_D:
    s_waitcnt vmcnt(0)
    s_barrier
    s_branch DOWN
SP_COMPUTE:
    s_mov_b32 s48, s28
    s_mov_b32 s49, s29
    s_mov_b32 s50, 16777216
    s_mov_b32 s51, 0x00020000
    s_mov_b32 s52, s24
    s_mov_b32 s53, s25
    s_mov_b32 s54, 2097152
    s_mov_b32 s55, 0x00020000
    v_and_b32 v14, 31, v1
    v_lshrrev_b32 v15, 5, v1
    v_bfe_u32 v16, v1, 1, 3
    v_xor_b32 v16, v16, v15
    s_and_b32 s60, s30, 1
    s_lshl_b32 s60, s60, 12
    s_add_u32 s60, s60, 0
    v_lshlrev_b32 v17, 7, v14
    v_add_u32 v17, s60, v17
    v_xor_b32 v18, 0, v16
    v_lshl_add_u32 v10, v18, 4, v17
    v_xor_b32 v18, 2, v16
    v_lshl_add_u32 v11, v18, 4, v17
    v_xor_b32 v18, 4, v16
    v_lshl_add_u32 v12, v18, 4, v17
    v_xor_b32 v18, 6, v16
    v_lshl_add_u32 v13, v18, 4, v17
    v_bfe_u32 v16, v1, 2, 2
    v_lshl_add_u32 v17, v15, 3, v16
    v_and_b32 v18, 3, v1
    v_lshlrev_b32 v18, 3, v18
    v_mov_b32 v64, 0
    v_mov_b32 v65, 0
    v_mov_b32 v66, 0
    v_mov_b32 v67, 0
    v_mov_b32 v68, 0
    v_mov_b32 v69, 0
    v_mov_b32 v70, 0
    v_mov_b32 v71, 0
    v_mov_b32 v72, 0
    v_mov_b32 v73, 0
    v_mov_b32 v74, 0
    v_mov_b32 v75, 0
    v_mov_b32 v76, 0
    v_mov_b32 v77, 0
    v_mov_b32 v78, 0
    v_mov_b32 v79, 0
    s_lshl_b32 s98, s97, 1
    s_and_b32 s60, s30, 1
    s_add_u32 s98, s98, s60
    s_waitcnt vmcnt(0)
    s_barrier
    s_lshr_b32 s99, s30, 1
    s_cmp_eq_u32 s99, 1
    s_cbranch_scc1 SPC_V
    s_cmp_eq_u32 s99, 2
    s_cbranch_scc1 SPC_G
    s_cmp_eq_u32 s99, 3
    s_cbranch_scc1 SPC_Q
    v_lshl_add_u32 v14, v17, 5, v18
    v_add_u32 v14, 65536, v14
    ds_read_b128 v[24:27], v10
    ds_read_b64_tr_b16 v[40:41], v14 offset:0
    ds_read_b64_tr_b16 v[42:43], v14 offset:128
    v_add_u32 v10, 0x2000, v10
    ds_read_b128 v[28:31], v11
    ds_read_b64_tr_b16 v[44:45], v14 offset:512
    ds_read_b64_tr_b16 v[46:47], v14 offset:640
    v_add_u32 v11, 0x2000, v11
    ds_read_b128 v[32:35], v12
    ds_read_b64_tr_b16 v[48:49], v14 offset:1024
    ds_read_b64_tr_b16 v[50:51], v14 offset:1152
    v_add_u32 v12, 0x2000, v12
    ds_read_b128 v[36:39], v13
    ds_read_b64_tr_b16 v[52:53], v14 offset:1536
    ds_read_b64_tr_b16 v[54:55], v14 offset:1664
    v_add_u32 v13, 0x2000, v13
    v_add_u32 v14, 2048, v14
    s_mov_b32 s60, 8
CH_21:
    s_waitcnt lgkmcnt(9)
    v_mfma_f32_32x32x16_bf16 v[64:79], v[40:43], v[24:27], v[64:79]
    ds_read_b128 v[24:27], v10
    ds_read_b64_tr_b16 v[40:41], v14 offset:0
    ds_read_b64_tr_b16 v[42:43], v14 offset:128
    v_add_u32 v10, 0x2000, v10
    s_waitcnt lgkmcnt(9)
    v_mfma_f32_32x32x16_bf16 v[64:79], v[44:47], v[28:31], v[64:79]
    ds_read_b128 v[28:31], v11
    ds_read_b64_tr_b16 v[44:45], v14 offset:512
    ds_read_b64_tr_b16 v[46:47], v14 offset:640
    v_add_u32 v11, 0x2000, v11
    s_waitcnt lgkmcnt(9)
    v_mfma_f32_32x32x16_bf16 v[64:79], v[48:51], v[32:35], v[64:79]
    ds_read_b128 v[32:35], v12
    ds_read_b64_tr_b16 v[48:49], v14 offset:1024
    ds_read_b64_tr_b16 v[50:51], v14 offset:1152
    v_add_u32 v12, 0x2000, v12
    s_waitcnt lgkmcnt(9)
    v_mfma_f32_32x32x16_bf16 v[64:79], v[52:55], v[36:39], v[64:79]
    ds_read_b128 v[36:39], v13
    ds_read_b64_tr_b16 v[52:53], v14 offset:1536
    ds_read_b64_tr_b16 v[54:55], v14 offset:1664
    v_add_u32 v13, 0x2000, v13
    v_add_u32 v14, 2048, v14
    s_sub_u32 s60, s60, 1
    s_cmp_lg_u32 s60, 0
    s_cbranch_scc1 CH_21
    s_waitcnt lgkmcnt(0)
    s_mov_b32 s60, 0x3eb8aa3b
    v_and_b32 v14, 0x33, v1
    v_bfe_u32 v15, v1, 2, 1
    v_lshl_add_u32 v14, v15, 3, v14
    v_bfe_u32 v15, v1, 3, 1
    v_lshl_add_u32 v14, v15, 2, v14
    v_lshlrev_b32 v14, 4, v14
    s_nop 4
    v_mul_f32 v64, s60, v64
    v_mul_f32 v65, s60, v65
    v_mul_f32 v66, s60, v66
    v_mul_f32 v67, s60, v67
    v_mul_f32 v68, s60, v68
    v_mul_f32 v69, s60, v69
    v_mul_f32 v70, s60, v70
    v_mul_f32 v71, s60, v71
    v_mul_f32 v18, v64, v64
    v_fmac_f32 v18, v65, v65
    v_fmac_f32 v18, v66, v66
    v_fmac_f32 v18, v67, v67
    v_fmac_f32 v18, v68, v68
    v_fmac_f32 v18, v69, v69
    v_fmac_f32 v18, v70, v70
    v_fmac_f32 v18, v71, v71
    v_cvt_pk_bf16_f32 v72, v64, v65
    v_cvt_pk_bf16_f32 v73, v66, v67
    v_cvt_pk_bf16_f32 v74, v68, v69
    v_cvt_pk_bf16_f32 v75, v70, v71
    s_lshl_b32 s60, s98, 11
    s_add_u32 s60, s60, 4194304
    buffer_store_dwordx4 v[72:75], v14, s[48:51], s60 offen sc1
    v_mov_b32 v19, v18
    s_nop 1
    v_permlane32_swap_b32 v18, v19
    s_nop 1
    v_add_f32 v18, v18, v19
    s_nop 1
    v_max_f32_dpp v18, v18, v18 quad_perm:[1,0,3,2] row_mask:0xf bank_mask:0xf
    s_nop 1
    v_max_f32_dpp v18, v18, v18 quad_perm:[2,3,0,1] row_mask:0xf bank_mask:0xf
    s_nop 1
    v_max_f32_dpp v18, v18, v18 row_half_mirror row_mask:0xf bank_mask:0xf
    s_nop 1
    v_max_f32_dpp v18, v18, v18 row_mirror row_mask:0xf bank_mask:0xf
    v_mov_b32 v19, v18
    s_nop 1
    v_permlane16_swap_b32 v18, v19
    s_nop 1
    v_max_f32 v18, v18, v19
    s_lshl_b32 s60, s98, 2
    s_add_u32 s60, s60, 4325376
    s_mov_b64 exec, 1
    buffer_store_dword v18, v3, s[48:51], s60 offen sc1
    s_mov_b64 exec, -1
    s_branch SPC_KV_DONE
SPC_V:
    v_lshl_add_u32 v14, v17, 5, v18
    v_add_u32 v14, 81920, v14
    ds_read_b128 v[24:27], v10
    ds_read_b64_tr_b16 v[40:41], v14 offset:0
    ds_read_b64_tr_b16 v[42:43], v14 offset:128
    v_add_u32 v10, 0x2000, v10
    ds_read_b128 v[28:31], v11
    ds_read_b64_tr_b16 v[44:45], v14 offset:512
    ds_read_b64_tr_b16 v[46:47], v14 offset:640
    v_add_u32 v11, 0x2000, v11
    ds_read_b128 v[32:35], v12
    ds_read_b64_tr_b16 v[48:49], v14 offset:1024
    ds_read_b64_tr_b16 v[50:51], v14 offset:1152
    v_add_u32 v12, 0x2000, v12
    ds_read_b128 v[36:39], v13
    ds_read_b64_tr_b16 v[52:53], v14 offset:1536
    ds_read_b64_tr_b16 v[54:55], v14 offset:1664
    v_add_u32 v13, 0x2000, v13
    v_add_u32 v14, 2048, v14
    s_mov_b32 s60, 8
CH_22:
    s_waitcnt lgkmcnt(9)
    v_mfma_f32_32x32x16_bf16 v[64:79], v[24:27], v[40:43], v[64:79]
    ds_read_b128 v[24:27], v10
    ds_read_b64_tr_b16 v[40:41], v14 offset:0
    ds_read_b64_tr_b16 v[42:43], v14 offset:128
    v_add_u32 v10, 0x2000, v10
    s_waitcnt lgkmcnt(9)
    v_mfma_f32_32x32x16_bf16 v[64:79], v[28:31], v[44:47], v[64:79]
    ds_read_b128 v[28:31], v11
    ds_read_b64_tr_b16 v[44:45], v14 offset:512
    ds_read_b64_tr_b16 v[46:47], v14 offset:640
    v_add_u32 v11, 0x2000, v11
    s_waitcnt lgkmcnt(9)
    v_mfma_f32_32x32x16_bf16 v[64:79], v[32:35], v[48:51], v[64:79]
    ds_read_b128 v[32:35], v12
    ds_read_b64_tr_b16 v[48:49], v14 offset:1024
    ds_read_b64_tr_b16 v[50:51], v14 offset:1152
    v_add_u32 v12, 0x2000, v12
    s_waitcnt lgkmcnt(9)
    v_mfma_f32_32x32x16_bf16 v[64:79], v[36:39], v[52:55], v[64:79]
    ds_read_b128 v[36:39], v13
    ds_read_b64_tr_b16 v[52:53], v14 offset:1536
    ds_read_b64_tr_b16 v[54:55], v14 offset:1664
    v_add_u32 v13, 0x2000, v13
    v_add_u32 v14, 2048, v14
    s_sub_u32 s60, s60, 1
    s_cmp_lg_u32 s60, 0
    s_cbranch_scc1 CH_22
    s_waitcnt lgkmcnt(0)
    s_nop 9
    v_cvt_pk_bf16_f32 v64, v64, v65
    v_cvt_pk_bf16_f32 v65, v66, v67
    v_cvt_pk_bf16_f32 v66, v68, v69
    v_cvt_pk_bf16_f32 v67, v70, v71
    v_cvt_pk_bf16_f32 v68, v72, v73
    v_cvt_pk_bf16_f32 v69, v74, v75
    v_cvt_pk_bf16_f32 v70, v76, v77
    v_cvt_pk_bf16_f32 v71, v78, v79
    s_lshl_b32 s60, s98, 11
    s_add_u32 s60, s60, 4195328
    s_mov_b32 exec_lo, 0xffff
    s_mov_b32 exec_hi, 0xffff
    buffer_store_dwordx4 v[64:67], v2, s[48:51], s60 offen sc1
    buffer_store_dwordx4 v[68:71], v2, s[48:51], s60 offen offset:256 sc1
    s_mov_b64 exec, -1
SPC_KV_DONE:
    s_waitcnt vmcnt(0)
    s_barrier
    s_barrier
    s_barrier
    s_barrier
    s_branch SPC_JOIN
SPC_G:
    s_barrier
    v_lshlrev_b32 v14, 4, v15
    v_add_u32 v14, 98304, v14
    ds_read_b128 v[24:27], v10
    ds_read_b128 v[40:43], v14 offset:0
    v_add_u32 v10, 0x2000, v10
    ds_read_b128 v[28:31], v11
    ds_read_b128 v[44:47], v14 offset:32
    v_add_u32 v11, 0x2000, v11
    ds_read_b128 v[32:35], v12
    ds_read_b128 v[48:51], v14 offset:64
    v_add_u32 v12, 0x2000, v12
    ds_read_b128 v[36:39], v13
    ds_read_b128 v[52:55], v14 offset:96
    v_add_u32 v13, 0x2000, v13
    v_add_u32 v14, 128, v14
    s_mov_b32 s60, 8
CH_23:
    s_waitcnt lgkmcnt(6)
    v_mfma_f32_32x32x16_bf16 v[64:79], v[40:43], v[24:27], v[64:79]
    ds_read_b128 v[24:27], v10
    ds_read_b128 v[40:43], v14 offset:0
    v_add_u32 v10, 0x2000, v10
    s_waitcnt lgkmcnt(6)
    v_mfma_f32_32x32x16_bf16 v[64:79], v[44:47], v[28:31], v[64:79]
    ds_read_b128 v[28:31], v11
    ds_read_b128 v[44:47], v14 offset:32
    v_add_u32 v11, 0x2000, v11
    s_waitcnt lgkmcnt(6)
    v_mfma_f32_32x32x16_bf16 v[64:79], v[48:51], v[32:35], v[64:79]
    ds_read_b128 v[32:35], v12
    ds_read_b128 v[48:51], v14 offset:64
    v_add_u32 v12, 0x2000, v12
    s_waitcnt lgkmcnt(6)
    v_mfma_f32_32x32x16_bf16 v[64:79], v[52:55], v[36:39], v[64:79]
    ds_read_b128 v[36:39], v13
    ds_read_b128 v[52:55], v14 offset:96
    v_add_u32 v13, 0x2000, v13
    v_add_u32 v14, 128, v14
    s_sub_u32 s60, s60, 1
    s_cmp_lg_u32 s60, 0
    s_cbranch_scc1 CH_23
    s_waitcnt lgkmcnt(0)
    s_barrier
    s_nop 9
    v_mul_f32 v18, 0xbfb8aa3b, v64
    v_exp_f32 v18, v18
    s_lshl_b32 s60, s98, 7
    v_add_f32 v18, 1.0, v18
    v_rcp_f32 v20, v18
    s_add_u32 s60, s60, 4329472
    s_mov_b32 exec_hi, 0
    buffer_store_dword v20, v3, s[48:51], s60 offen sc1
    s_mov_b64 exec, -1
    v_and_b32 v14, 31, v1
    v_lshrrev_b32 v15, 5, v1
    v_bfe_u32 v16, v1, 1, 3
    v_xor_b32 v16, v16, v15
    s_and_b32 s60, s30, 1
    s_lshl_b32 s60, s60, 12
    s_add_u32 s60, s60, 65536
    v_lshlrev_b32 v17, 7, v14
    v_add_u32 v17, s60, v17
    v_xor_b32 v18, 0, v16
    v_lshl_add_u32 v10, v18, 4, v17
    v_xor_b32 v18, 2, v16
    v_lshl_add_u32 v11, v18, 4, v17
    v_xor_b32 v18, 4, v16
    v_lshl_add_u32 v12, v18, 4, v17
    v_xor_b32 v18, 6, v16
    v_lshl_add_u32 v13, v18, 4, v17
    v_bfe_u32 v16, v1, 2, 2
    v_lshl_add_u32 v17, v15, 3, v16
    v_and_b32 v18, 3, v1
    v_lshlrev_b32 v18, 3, v18
    v_mov_b32 v64, 0
    v_mov_b32 v65, 0
    v_mov_b32 v66, 0
    v_mov_b32 v67, 0
    v_mov_b32 v68, 0
    v_mov_b32 v69, 0
    v_mov_b32 v70, 0
    v_mov_b32 v71, 0
    v_mov_b32 v72, 0
    v_mov_b32 v73, 0
    v_mov_b32 v74, 0
    v_mov_b32 v75, 0
    v_mov_b32 v76, 0
    v_mov_b32 v77, 0
    v_mov_b32 v78, 0
    v_mov_b32 v79, 0
    s_xor_b32 s98, s98, 2
    s_waitcnt vmcnt(0)
    s_barrier
    v_lshl_add_u32 v14, v17, 6, v18
    v_bfe_u32 v19, v1, 4, 1
    v_lshl_add_u32 v14, v19, 5, v14
    v_add_u32 v14, 131072, v14
    ds_read_b128 v[24:27], v10
    ds_read_b64_tr_b16 v[40:41], v14 offset:0
    ds_read_b64_tr_b16 v[42:43], v14 offset:256
    v_add_u32 v10, 0x2000, v10
    ds_read_b128 v[28:31], v11
    ds_read_b64_tr_b16 v[44:45], v14 offset:1024
    ds_read_b64_tr_b16 v[46:47], v14 offset:1280
    v_add_u32 v11, 0x2000, v11
    ds_read_b128 v[32:35], v12
    ds_read_b64_tr_b16 v[48:49], v14 offset:2048
    ds_read_b64_tr_b16 v[50:51], v14 offset:2304
    v_add_u32 v12, 0x2000, v12
    ds_read_b128 v[36:39], v13
    ds_read_b64_tr_b16 v[52:53], v14 offset:3072
    ds_read_b64_tr_b16 v[54:55], v14 offset:3328
    v_add_u32 v13, 0x2000, v13
    v_add_u32 v14, 4096, v14
    s_mov_b32 s60, 8
CH_24:
    s_waitcnt lgkmcnt(9)
    v_mfma_f32_32x32x16_bf16 v[64:79], v[40:43], v[24:27], v[64:79]
    ds_read_b128 v[24:27], v10
    ds_read_b64_tr_b16 v[40:41], v14 offset:0
    ds_read_b64_tr_b16 v[42:43], v14 offset:256
    v_add_u32 v10, 0x2000, v10
    s_waitcnt lgkmcnt(9)
    v_mfma_f32_32x32x16_bf16 v[64:79], v[44:47], v[28:31], v[64:79]
    ds_read_b128 v[28:31], v11
    ds_read_b64_tr_b16 v[44:45], v14 offset:1024
    ds_read_b64_tr_b16 v[46:47], v14 offset:1280
    v_add_u32 v11, 0x2000, v11
    s_waitcnt lgkmcnt(9)
    v_mfma_f32_32x32x16_bf16 v[64:79], v[48:51], v[32:35], v[64:79]
    ds_read_b128 v[32:35], v12
    ds_read_b64_tr_b16 v[48:49], v14 offset:2048
    ds_read_b64_tr_b16 v[50:51], v14 offset:2304
    v_add_u32 v12, 0x2000, v12
    s_waitcnt lgkmcnt(9)
    v_mfma_f32_32x32x16_bf16 v[64:79], v[52:55], v[36:39], v[64:79]
    ds_read_b128 v[36:39], v13
    ds_read_b64_tr_b16 v[52:53], v14 offset:3072
    ds_read_b64_tr_b16 v[54:55], v14 offset:3328
    v_add_u32 v13, 0x2000, v13
    v_add_u32 v14, 4096, v14
    s_sub_u32 s60, s60, 1
    s_cmp_lg_u32 s60, 0
    s_cbranch_scc1 CH_24
    s_waitcnt lgkmcnt(0)
    s_branch SPC_QW
SPC_Q:
    s_barrier
    v_lshl_add_u32 v14, v17, 6, v18
    v_bfe_u32 v19, v1, 4, 1
    v_lshl_add_u32 v14, v19, 5, v14
    v_add_u32 v14, 131072, v14
    ds_read_b128 v[24:27], v10
    ds_read_b64_tr_b16 v[40:41], v14 offset:0
    ds_read_b64_tr_b16 v[42:43], v14 offset:256
    v_add_u32 v10, 0x2000, v10
    ds_read_b128 v[28:31], v11
    ds_read_b64_tr_b16 v[44:45], v14 offset:1024
    ds_read_b64_tr_b16 v[46:47], v14 offset:1280
    v_add_u32 v11, 0x2000, v11
    ds_read_b128 v[32:35], v12
    ds_read_b64_tr_b16 v[48:49], v14 offset:2048
    ds_read_b64_tr_b16 v[50:51], v14 offset:2304
    v_add_u32 v12, 0x2000, v12
    ds_read_b128 v[36:39], v13
    ds_read_b64_tr_b16 v[52:53], v14 offset:3072
    ds_read_b64_tr_b16 v[54:55], v14 offset:3328
    v_add_u32 v13, 0x2000, v13
    v_add_u32 v14, 4096, v14
    s_mov_b32 s60, 8
CH_25:
    s_waitcnt lgkmcnt(9)
    v_mfma_f32_32x32x16_bf16 v[64:79], v[40:43], v[24:27], v[64:79]
    ds_read_b128 v[24:27], v10
    ds_read_b64_tr_b16 v[40:41], v14 offset:0
    ds_read_b64_tr_b16 v[42:43], v14 offset:256
    v_add_u32 v10, 0x2000, v10
    s_waitcnt lgkmcnt(9)
    v_mfma_f32_32x32x16_bf16 v[64:79], v[44:47], v[28:31], v[64:79]
    ds_read_b128 v[28:31], v11
    ds_read_b64_tr_b16 v[44:45], v14 offset:1024
    ds_read_b64_tr_b16 v[46:47], v14 offset:1280
    v_add_u32 v11, 0x2000, v11
    s_waitcnt lgkmcnt(9)
    v_mfma_f32_32x32x16_bf16 v[64:79], v[48:51], v[32:35], v[64:79]
    ds_read_b128 v[32:35], v12
    ds_read_b64_tr_b16 v[48:49], v14 offset:2048
    ds_read_b64_tr_b16 v[50:51], v14 offset:2304
    v_add_u32 v12, 0x2000, v12
    s_waitcnt lgkmcnt(9)
    v_mfma_f32_32x32x16_bf16 v[64:79], v[52:55], v[36:39], v[64:79]
    ds_read_b128 v[36:39], v13
    ds_read_b64_tr_b16 v[52:53], v14 offset:3072
    ds_read_b64_tr_b16 v[54:55], v14 offset:3328
    v_add_u32 v13, 0x2000, v13
    v_add_u32 v14, 4096, v14
    s_sub_u32 s60, s60, 1
    s_cmp_lg_u32 s60, 0
    s_cbranch_scc1 CH_25
    s_waitcnt lgkmcnt(0)
    s_barrier
    s_barrier
SPC_QW:
    s_barrier
    s_and_b32 s60, s98, 3
    s_nop 2
    s_lshl_b32 s60, s60, 12
    s_add_u32 s60, s60, 131072
    v_add_u32 v14, s60, v2
    v_xor_b32 v15, 0x4000, v14
    s_nop 3
    v_cvt_pk_bf16_f32 v64, v64, v65
    v_cvt_pk_bf16_f32 v65, v66, v67
    v_cvt_pk_bf16_f32 v66, v68, v69
    v_cvt_pk_bf16_f32 v67, v70, v71
    v_cvt_pk_bf16_f32 v68, v72, v73
    v_cvt_pk_bf16_f32 v69, v74, v75
    v_cvt_pk_bf16_f32 v70, v76, v77
    v_cvt_pk_bf16_f32 v71, v78, v79
    ds_write_b128 v14, v[64:67]
    ds_write_b128 v15, v[68:71]
    s_waitcnt lgkmcnt(0)
SPC_JOIN:
    s_mov_b32 s60, 4325376
    buffer_load_dword v10, v3, s[48:51], s60 offen sc1
    s_lshl_b32 s62, s30, 12
    s_add_u32 s62, s62, 131072
    v_add_u32 v14, s62, v2
    s_barrier
    ds_read_b128 v[48:51], v14
    v_and_b32 v12, 27, v1
    v_cmp_eq_u32 vcc, 16, v12
    v_mov_b32 v12, 0x3f803f80
    v_mov_b32 v8, 0xdddd
    v_cndmask_b32 v32, 0, v12, vcc
    v_mov_b32 v33, v32
    v_mov_b64 v[34:35], v[32:33]
    v_mov_b64 v[36:37], v[32:33]
    v_mov_b64 v[38:39], v[32:33]
    v_mov_b64 v[40:41], v[32:33]
    v_mov_b64 v[42:43], v[32:33]
    v_mov_b64 v[44:45], v[32:33]
    v_mov_b64 v[46:47], v[32:33]
    v_mov_b64 v[16:17], 0
    v_mov_b64 v[18:19], 0
    v_mov_b64 v[20:21], 0
    v_mov_b64 v[22:23], 0
    v_mov_b64 v[24:25], 0
    v_mov_b64 v[26:27], 0
    v_mov_b64 v[28:29], 0
    v_mov_b64 v[30:31], 0
    v_mov_b32 v13, v2
    v_mov_b32 v11, 0
    s_waitcnt vmcnt(0)
    s_nop 1
    v_max_f32_dpp v10, v10, v10 quad_perm:[1,0,3,2] row_mask:0xf bank_mask:0xf
    s_nop 1
    v_max_f32_dpp v10, v10, v10 quad_perm:[2,3,0,1] row_mask:0xf bank_mask:0xf
    s_nop 1
    v_max_f32_dpp v10, v10, v10 row_half_mirror row_mask:0xf bank_mask:0xf
    s_nop 1
    v_max_f32_dpp v10, v10, v10 row_mirror row_mask:0xf bank_mask:0xf
    v_mov_b32 v12, v10
    s_nop 1
    v_permlane16_swap_b32 v10, v12
    s_nop 1
    v_max_f32 v10, v10, v12
    v_mov_b32 v12, v10
    s_nop 1
    v_permlane32_swap_b32 v10, v12
    s_nop 1
    v_max_f32 v10, v10, v12
    s_waitcnt lgkmcnt(0)
    s_branch QJOIN
CODE_END:
.section .rodata,"a"
.p2align 6
.amdhsa_kernel gated_mix__grouped_kv_mqa__glu_gated_glu__prompt_kernel
  .amdhsa_next_free_vgpr 168
  .amdhsa_next_free_sgpr 102
  .amdhsa_accum_offset 168
  .amdhsa_group_segment_fixed_size 0
  .amdhsa_kernarg_size 104
  .amdhsa_user_sgpr_count 2
  .amdhsa_user_sgpr_kernarg_segment_ptr 1
  .amdhsa_system_sgpr_workgroup_id_x 1
.end_amdhsa_kernel
```
